```python
import torch

def _softmax(x, axis=-1):
    return torch.softmax(x, dim=axis)
def _gelu(x):
    return torch.nn.functional.gelu(x, approximate="tanh")
def _silu(x):
    return torch.nn.functional.silu(x)
def _sigmoid(x):
    return torch.sigmoid(x)
def _layernorm(x, axis=-1, eps=1e-5):
    m = x.mean(dim=axis, keepdim=True)
    v = x.var(dim=axis, keepdim=True, unbiased=False)
    return (x - m) / torch.sqrt(v + eps)
def _scatter_add(tgt, idx, src, axis=0):
    return tgt.clone().index_add_(axis, idx, src)
def _segment_sum(src, seg, n):
    out = torch.zeros((n,) + src.shape[1:], dtype=src.dtype)
    return out.index_add_(0, seg, src)
def _pad(x, pw):
    flat = tuple(v for pair in reversed(pw) for v in pair)
    return torch.nn.functional.pad(x, flat)

kernel_name = 'parallel_sum__sliding_block_cached__geglu_ffn__decode'

def setup_inputs():

    _w = (lambda a: (lambda t: t.to(torch.bfloat16) if t.is_floating_point() else t)(torch.as_tensor(a)))
    def _A_setup():
        B, Sq, D = 8, 1, 576
        Hq, Hkv, Sk, Dh = 32, 16, 8192, 128
        assert Hq % Hkv == 0, (Hq, Hkv)
        return {
            "x": _w((lambda *s: torch.randn(*s, dtype=torch.bfloat16) * 0.05)(B, Sq, D)),
            "k_cache": _w((lambda *s: torch.randn(*s, dtype=torch.bfloat16) * 3.2)(B, Hkv, Sk, Dh)),
            "v_cache": _w((lambda *s: torch.randn(*s, dtype=torch.bfloat16) * 1.6)(B, Hkv, Sk, Dh)),
            "wq": _w((lambda *s: torch.randn(*s, dtype=torch.bfloat16) * 3.2)(D, Hq * Dh) * (D ** -0.5)),
            "wo": _w((lambda *s: torch.randn(*s, dtype=torch.bfloat16) * 1.6)(Hq * Dh, D) * ((Hq * Dh) ** -0.5)),
        }
    _A_in = _A_setup()

    def _B_setup():
        B, S, D, F = 8, 1, 576, 4608
        return {
            "x": _w((lambda *s: torch.randn(*s, dtype=torch.bfloat16) * 0.05)(B, S, D)),
            "w_gate": _w((lambda *s: torch.randn(*s, dtype=torch.bfloat16) * 0.05)(D, F)),
            "w_up": _w((lambda *s: torch.randn(*s, dtype=torch.bfloat16) * 0.05)(D, F)),
            "w_down": _w((lambda *s: torch.randn(*s, dtype=torch.bfloat16) * 0.05)(F, D)),
        }
    _B_in = _B_setup()

    return {
        "A_x": _A_in["x"],
        "A_k_cache": _A_in["k_cache"],
        "A_v_cache": _A_in["v_cache"],
        "A_wq": _A_in["wq"],
        "A_wo": _A_in["wo"],
        "B_x": _B_in["x"],
        "B_w_gate": _B_in["w_gate"],
        "B_w_up": _B_in["w_up"],
        "B_w_down": _B_in["w_down"],
    }

def reference(A_x, A_k_cache, A_v_cache, A_wq, A_wo, B_x, B_w_gate, B_w_up, B_w_down):
    def _A_ref(x, k_cache, v_cache, wq, wo):
        B, Sq, D = x.shape
        Hq, Dh = 32, 128
        Hkv, Sk = k_cache.shape[1], k_cache.shape[2]
        W = min(4096, max(256, Sk // 4))
        rep = Hq // Hkv
        q = (lambda x, *d: x.permute(*d))((x @ wq).reshape(B, Sq, Hq, Dh), 0, 2, 1, 3)
        k = (lambda x, n, axis: torch.repeat_interleave(x, n, dim=axis))(k_cache[:, :, Sk - W:, :], rep, axis=1)
        v = (lambda x, n, axis: torch.repeat_interleave(x, n, dim=axis))(v_cache[:, :, Sk - W:, :], rep, axis=1)
        scores = torch.einsum("bhqd,bhkd->bhqk", q, k) * (Dh ** -0.5)
        p = _softmax(scores, axis=-1)
        o = torch.einsum("bhqk,bhkd->bhqd", p, v)
        return (lambda x, *d: x.permute(*d))(o, 0, 2, 1, 3).reshape(B, Sq, Hq * Dh) @ wo

    def _B_ref(x, w_gate, w_up, w_down):
        return (_gelu(x @ w_gate) * (x @ w_up)) @ w_down

    x = A_x
    xn = _layernorm(x, axis=-1)
    return x + _A_ref(xn, A_k_cache, A_v_cache, A_wq, A_wo) + _B_ref(xn, B_w_gate, B_w_up, B_w_down)
```

```asm
; @launch grid=(256,1,1) block=(512,1,1) lds=26624
.amdgcn_target "amdgcn-amd-amdhsa--gfx950"
.text
.globl parallel_sum__sliding_block_cached__geglu_ffn__decode_kernel
.p2align 8
.type parallel_sum__sliding_block_cached__geglu_ffn__decode_kernel,@function
parallel_sum__sliding_block_cached__geglu_ffn__decode_kernel:
    s_cmp_ge_u32 s2, 256
    s_cbranch_scc1 L_end
    s_load_dwordx16 s[16:31], s[0:1], 0
    s_load_dwordx8 s[32:39], s[0:1], 64
    v_lshrrev_b32 v1, 6, v0
    v_and_b32 v0, 63, v0
    v_readfirstlane_b32 s3, v1
    s_and_b32 s6, s2, 7
    s_lshl_b32 s6, s6, 1
    s_bfe_u32 s7, s2, 0x10003
    s_or_b32 s6, s6, s7
    s_and_b32 s7, s2, 0x70
    s_or_b32 s6, s6, s7
    s_lshr_b32 s7, s2, 7
    s_cmp_lt_u32 s3, 4
    s_cbranch_scc1 L_stream
    s_cmp_lg_u32 s3, 5
    s_cbranch_scc1 L_help
    s_getpc_b64 s[4:5]
L_pc:
    s_bfe_u32 s8, s2, 0x20003
    s_mul_i32 s8, s8, 64
    v_add_u32 v1, s8, v0
    v_lshlrev_b32 v1, 7, v1
    v_min_u32 v1, L_codeend-L_pc-4, v1
    v_mov_b32 v3, s5
    v_add_co_u32 v2, vcc, s4, v1
    s_nop 1
    v_addc_co_u32 v3, vcc, 0, v3, vcc
    global_load_dword v255, v[2:3], off
    s_branch L_help
L_stream:
    v_lshrrev_b32 v3, 4, v0
    v_lshlrev_b32 v3, 6, v3
    v_and_b32 v4, 3, v0
    v_lshl_or_b32 v3, v4, 4, v3
    v_bfe_u32 v4, v0, 2, 1
    v_lshl_or_b32 v3, v4, 8, v3
    v_bfe_u32 v4, v0, 3, 1
    v_lshl_or_b32 v1, v4, 10, v3
    s_lshl_b32 s14, s6, 21
    s_lshl_b32 s15, s7, 16
    s_add_u32 s14, s14, s15
    s_add_u32 s14, s14, 1572864
    s_and_b32 s15, s3, 1
    s_lshl_b32 s15, s15, 9
    s_add_u32 s14, s14, s15
    s_lshr_b32 s15, s3, 1
    s_lshl_b32 s15, s15, 11
    s_add_u32 s14, s14, s15
    s_mov_b32 s42, 0x10000000
    s_mov_b32 s43, 0x20000
    s_waitcnt lgkmcnt(0)
    s_mov_b32 s40, s18
    s_mov_b32 s41, s19
    s_add_u32 s10, s14, 0
    buffer_load_dwordx4 v[36:39], v1, s[40:43], s10 offen nt
    s_branch L_smain
L_help:
    v_lshlrev_b32 v1, 4, v0
    s_mov_b32 s12, 0x05040100
    s_mov_b32 s13, 0x07060302
    s_cmp_eq_u32 s3, 5
    s_cbranch_scc1 L_h5
    s_lshr_b32 s101, s2, 3
    s_and_b32 s4, s2, 7
    s_cmp_lt_u32 s101, 8
    s_movk_i32 s14, 8192
    s_cselect_b32 s14, s14, 9216
    s_mov_b32 s58, 4718592
    s_cselect_b32 s58, s58, 5308416
    s_cselect_b32 s5, 8, 9
    s_cselect_b32 s15, 0, 8
    s_mul_i32 s4, s4, s5
    s_cmp_lt_u32 s101, 17
    s_cselect_b32 s15, s15, 17
    s_sub_u32 s15, s101, s15
    s_add_u32 s74, s15, s4
    s_lshl_b32 s15, s74, 7
    v_lshrrev_b32 v3, 3, v0
    v_mul_u32_u24 v3, s14, v3
    v_and_b32 v2, 7, v0
    v_lshl_add_u32 v2, v2, 4, v3
    s_sub_u32 s10, s3, 5
    s_max_i32 s10, s10, 0
    s_mul_i32 s4, s10, 192
    s_mul_i32 s4, s4, s14
    s_add_u32 s15, s15, s4
    s_lshl_b32 s14, s14, 3
    s_mov_b32 s59, 0x20000
    s_waitcnt lgkmcnt(0)
    s_cmp_ge_u32 s2, 208
    s_cbranch_scc1 L_nol1
    s_cmp_lt_u32 s101, 17
    s_cselect_b32 s56, s28, s30
    s_cselect_b32 s57, s29, s31
    s_cmp_lt_u32 s101, 8
    s_cselect_b32 s56, s22, s56
    s_cselect_b32 s57, s23, s57
    buffer_load_dwordx4 v[116:119], v2, s[56:59], s15 offen nt
    s_add_u32 s15, s15, s14
    buffer_load_dwordx4 v[120:123], v2, s[56:59], s15 offen nt
    s_add_u32 s15, s15, s14
    buffer_load_dwordx4 v[124:127], v2, s[56:59], s15 offen nt
    s_add_u32 s15, s15, s14
    buffer_load_dwordx4 v[128:131], v2, s[56:59], s15 offen nt
    s_add_u32 s15, s15, s14
    buffer_load_dwordx4 v[132:135], v2, s[56:59], s15 offen nt
    s_add_u32 s15, s15, s14
    buffer_load_dwordx4 v[136:139], v2, s[56:59], s15 offen nt
    s_add_u32 s15, s15, s14
    buffer_load_dwordx4 v[140:143], v2, s[56:59], s15 offen nt
    s_add_u32 s15, s15, s14
    s_mov_b32 s52, s38
    s_mov_b32 s53, s39
    s_mov_b32 s54, 0x40000000
    s_mov_b32 s55, 0x20000
    s_barrier
    s_waitcnt vmcnt(6)
    buffer_load_dwordx4 v[144:147], v2, s[56:59], s15 offen nt
    s_add_u32 s15, s15, s14
    s_waitcnt vmcnt(6)
    buffer_load_dwordx4 v[148:151], v2, s[56:59], s15 offen nt
    s_add_u32 s15, s15, s14
    s_waitcnt vmcnt(6)
    buffer_load_dwordx4 v[152:155], v2, s[56:59], s15 offen nt
    s_add_u32 s15, s15, s14
    s_waitcnt vmcnt(6)
    buffer_load_dwordx4 v[156:159], v2, s[56:59], s15 offen nt
    s_add_u32 s15, s15, s14
    s_waitcnt vmcnt(6)
    buffer_load_dwordx4 v[160:163], v2, s[56:59], s15 offen nt
    s_add_u32 s15, s15, s14
    s_waitcnt vmcnt(6)
    buffer_load_dwordx4 v[164:167], v2, s[56:59], s15 offen nt
    s_add_u32 s15, s15, s14
    s_waitcnt vmcnt(6)
    buffer_load_dwordx4 v[168:171], v2, s[56:59], s15 offen nt
    s_add_u32 s15, s15, s14
    s_waitcnt vmcnt(6)
    buffer_load_dwordx4 v[172:175], v2, s[56:59], s15 offen nt
    s_add_u32 s15, s15, s14
    s_waitcnt vmcnt(6)
    buffer_load_dwordx4 v[176:179], v2, s[56:59], s15 offen nt
    s_add_u32 s15, s15, s14
    s_waitcnt vmcnt(6)
    buffer_load_dwordx4 v[180:183], v2, s[56:59], s15 offen nt
    s_add_u32 s15, s15, s14
    s_waitcnt vmcnt(6)
    buffer_load_dwordx4 v[184:187], v2, s[56:59], s15 offen nt
    s_add_u32 s15, s15, s14
    s_waitcnt vmcnt(6)
    buffer_load_dwordx4 v[188:191], v2, s[56:59], s15 offen nt
    s_add_u32 s15, s15, s14
    s_waitcnt vmcnt(6)
    buffer_load_dwordx4 v[192:195], v2, s[56:59], s15 offen nt
    s_add_u32 s15, s15, s14
    s_waitcnt vmcnt(6)
    buffer_load_dwordx4 v[196:199], v2, s[56:59], s15 offen nt
    s_add_u32 s15, s15, s14
    s_waitcnt vmcnt(6)
    buffer_load_dwordx4 v[200:203], v2, s[56:59], s15 offen nt
    s_add_u32 s15, s15, s14
    s_waitcnt vmcnt(6)
    buffer_load_dwordx4 v[204:207], v2, s[56:59], s15 offen nt
    s_add_u32 s15, s15, s14
    s_waitcnt vmcnt(6)
    buffer_load_dwordx4 v[208:211], v2, s[56:59], s15 offen nt
    s_add_u32 s15, s15, s14
    s_branch L_amain
L_smain:
    s_mov_b32 s44, s20
    s_mov_b32 s45, s21
    s_mov_b32 s46, 0x10000000
    s_mov_b32 s47, 0x20000
    s_mov_b32 s52, s38
    s_mov_b32 s53, s39
    s_mov_b32 s54, 0x40000000
    s_mov_b32 s55, 0x20000
    v_and_b32 v3, 15, v0
    v_lshlrev_b32 v3, 4, v3
    v_bfe_u32 v4, v0, 4, 1
    v_lshl_or_b32 v3, v4, 8, v3
    v_lshrrev_b32 v4, 5, v0
    v_lshl_or_b32 v2, v4, 10, v3
    v_bfe_u32 v3, v0, 3, 1
    v_bfe_u32 v4, v0, 1, 1
    v_lshl_or_b32 v3, v3, 1, v4
    v_and_b32 v4, 1, v0
    v_lshlrev_b32 v4, 4, v4
    v_mov_b32 v5, 0xffff
    v_lshlrev_b32 v4, v4, v5
    v_cmp_eq_u32 vcc, 0, v3
    s_nop 1
    v_cndmask_b32 v12, 0, v4, vcc
    v_cmp_eq_u32 vcc, 1, v3
    s_nop 1
    v_cndmask_b32 v13, 0, v4, vcc
    v_cmp_eq_u32 vcc, 2, v3
    s_nop 1
    v_cndmask_b32 v14, 0, v4, vcc
    v_cmp_eq_u32 vcc, 3, v3
    s_nop 1
    v_cndmask_b32 v15, 0, v4, vcc
    s_and_b32 s4, s6, 15
    s_lshl_b32 s4, s4, 13
    s_lshr_b32 s5, s6, 4
    s_lshl_b32 s5, s5, 1
    s_add_u32 s5, s5, s7
    s_lshl_b32 s5, s5, 6
    s_add_u32 s4, s4, s5
    s_add_u32 s26, s4, 1048576
    s_lshl_b32 s5, s3, 11
    s_add_u32 s26, s26, s5
    s_lshl_b32 s4, s3, 2
    v_lshlrev_b32 v9, 4, v0
    v_add_u32 v8, s4, v9
    v_mov_b32 v253, 0
    s_mov_b32 s27, 0
    s_barrier
    s_cmp_ge_u32 s2, 208
    s_cbranch_scc1 L_go_ok
    s_mov_b32 s48, s16
    s_mov_b32 s49, s17
    s_mov_b32 s50, 9216
    s_mov_b32 s51, 0x20000
    v_lshrrev_b32 v3, 5, v0
    v_mul_u32_u24 v3, 1152, v3
    v_and_b32 v4, 31, v0
    v_lshl_add_u32 v3, v4, 2, v3
    s_mul_i32 s4, s3, 2304
    buffer_load_dword v248, v3, s[48:51], s4 offen offset:0
    buffer_load_dword v249, v3, s[48:51], s4 offen offset:128
    buffer_load_dword v250, v3, s[48:51], s4 offen offset:256
    buffer_load_dword v251, v3, s[48:51], s4 offen offset:384
    buffer_load_dword v244, v3, s[48:51], s4 offen offset:512
    buffer_load_dword v245, v3, s[48:51], s4 offen offset:640
    buffer_load_dword v246, v3, s[48:51], s4 offen offset:768
    buffer_load_dword v247, v3, s[48:51], s4 offen offset:896
    buffer_load_dword v240, v3, s[48:51], s4 offen offset:1024
    v_and_b32 v4, 3, v0
    v_lshlrev_b32 v11, 8, v4
    v_bfe_u32 v4, v0, 2, 3
    v_lshl_or_b32 v11, v4, 1, v11
    v_lshrrev_b32 v4, 5, v0
    v_lshl_or_b32 v11, v4, 5, v11
    s_lshl_b32 s4, s3, 6
    v_add_u32 v11, s4, v11
    s_waitcnt vmcnt(0)
    v_lshlrev_b32 v236, 16, v248
    v_and_b32 v237, 0xffff0000, v248
    v_lshlrev_b32 v238, 16, v249
    v_and_b32 v239, 0xffff0000, v249
    v_lshlrev_b32 v232, 16, v250
    v_and_b32 v233, 0xffff0000, v250
    v_lshlrev_b32 v234, 16, v251
    v_and_b32 v235, 0xffff0000, v251
    v_lshlrev_b32 v228, 16, v244
    v_and_b32 v229, 0xffff0000, v244
    v_lshlrev_b32 v230, 16, v245
    v_and_b32 v231, 0xffff0000, v245
    v_lshlrev_b32 v224, 16, v246
    v_and_b32 v225, 0xffff0000, v246
    v_lshlrev_b32 v226, 16, v247
    v_and_b32 v227, 0xffff0000, v247
    v_lshlrev_b32 v220, 16, v240
    v_and_b32 v221, 0xffff0000, v240
    v_pk_add_f32 v[4:5], v[236:237], v[238:239]
    v_pk_add_f32 v[4:5], v[4:5], v[232:233]
    v_pk_add_f32 v[4:5], v[4:5], v[234:235]
    v_pk_add_f32 v[4:5], v[4:5], v[228:229]
    v_pk_add_f32 v[4:5], v[4:5], v[230:231]
    v_pk_add_f32 v[4:5], v[4:5], v[224:225]
    v_pk_add_f32 v[4:5], v[4:5], v[226:227]
    v_pk_add_f32 v[4:5], v[4:5], v[220:221]
    v_add_f32 v10, v4, v5
    s_nop 1
    v_add_f32_dpp v10, v10, v10 row_ror:8 row_mask:0xf bank_mask:0xf
    s_nop 1
    v_add_f32_dpp v10, v10, v10 row_ror:4 row_mask:0xf bank_mask:0xf
    s_nop 1
    v_add_f32_dpp v10, v10, v10 row_ror:2 row_mask:0xf bank_mask:0xf
    s_nop 1
    v_add_f32_dpp v10, v10, v10 row_ror:1 row_mask:0xf bank_mask:0xf
    v_mov_b32 v3, v10
    s_nop 1
    v_permlane16_swap_b32 v10, v3
    v_add_f32 v10, v10, v3
    v_mul_f32 v10, 0x3ae38e39, v10
    v_mov_b32 v4, v10
    v_cvt_pk_bf16_f32 v4, v4, v4
    v_and_b32 v4, 0xffff0000, v4
    v_sub_f32 v10, v10, v4
    v_sub_f32 v4, 0, v4
    v_mov_b32 v5, v4
    v_pk_add_f32 v[236:237], v[236:237], v[4:5]
    v_pk_add_f32 v[238:239], v[238:239], v[4:5]
    v_pk_add_f32 v[232:233], v[232:233], v[4:5]
    v_pk_add_f32 v[234:235], v[234:235], v[4:5]
    v_pk_add_f32 v[228:229], v[228:229], v[4:5]
    v_pk_add_f32 v[230:231], v[230:231], v[4:5]
    v_pk_add_f32 v[224:225], v[224:225], v[4:5]
    v_pk_add_f32 v[226:227], v[226:227], v[4:5]
    v_pk_add_f32 v[220:221], v[220:221], v[4:5]
    v_pk_mul_f32 v[6:7], v[236:237], v[236:237]
    v_pk_fma_f32 v[6:7], v[238:239], v[238:239], v[6:7]
    v_pk_fma_f32 v[6:7], v[232:233], v[232:233], v[6:7]
    v_pk_fma_f32 v[6:7], v[234:235], v[234:235], v[6:7]
    v_pk_fma_f32 v[6:7], v[228:229], v[228:229], v[6:7]
    v_pk_fma_f32 v[6:7], v[230:231], v[230:231], v[6:7]
    v_pk_fma_f32 v[6:7], v[224:225], v[224:225], v[6:7]
    v_pk_fma_f32 v[6:7], v[226:227], v[226:227], v[6:7]
    v_pk_fma_f32 v[6:7], v[220:221], v[220:221], v[6:7]
    v_add_f32 v4, v6, v7
    s_nop 1
    v_add_f32_dpp v4, v4, v4 row_ror:8 row_mask:0xf bank_mask:0xf
    s_nop 1
    v_add_f32_dpp v4, v4, v4 row_ror:4 row_mask:0xf bank_mask:0xf
    s_nop 1
    v_add_f32_dpp v4, v4, v4 row_ror:2 row_mask:0xf bank_mask:0xf
    s_nop 1
    v_add_f32_dpp v4, v4, v4 row_ror:1 row_mask:0xf bank_mask:0xf
    v_mov_b32 v3, v4
    s_nop 1
    v_permlane16_swap_b32 v4, v3
    v_add_f32 v4, v4, v3
    v_mul_f32 v4, 0x3ae38e39, v4
    v_fma_f32 v4, -v10, v10, v4
    v_max_f32 v4, 0, v4
    v_cvt_pk_bf16_f32 v4, v4, v4
    v_and_b32 v4, 0xffff0000, v4
    v_add_f32 v4, 0x3727c5ac, v4
    v_cvt_pk_bf16_f32 v4, v4, v4
    v_and_b32 v4, 0xffff0000, v4
    v_sqrt_f32 v4, v4
    s_nop 0
    v_cvt_pk_bf16_f32 v4, v4, v4
    v_and_b32 v4, 0xffff0000, v4
    v_rcp_f32 v4, v4
    v_cvt_pk_bf16_f32 v248, v236, v237
    v_cvt_pk_bf16_f32 v249, v238, v239
    v_cvt_pk_bf16_f32 v250, v232, v233
    v_cvt_pk_bf16_f32 v251, v234, v235
    v_cvt_pk_bf16_f32 v244, v228, v229
    v_cvt_pk_bf16_f32 v245, v230, v231
    v_cvt_pk_bf16_f32 v246, v224, v225
    v_cvt_pk_bf16_f32 v247, v226, v227
    v_cvt_pk_bf16_f32 v240, v220, v221
    v_mov_b32 v5, v4
    v_lshlrev_b32 v236, 16, v248
    v_and_b32 v237, 0xffff0000, v248
    v_lshlrev_b32 v238, 16, v249
    v_and_b32 v239, 0xffff0000, v249
    v_lshlrev_b32 v232, 16, v250
    v_and_b32 v233, 0xffff0000, v250
    v_lshlrev_b32 v234, 16, v251
    v_and_b32 v235, 0xffff0000, v251
    v_lshlrev_b32 v228, 16, v244
    v_and_b32 v229, 0xffff0000, v244
    v_lshlrev_b32 v230, 16, v245
    v_and_b32 v231, 0xffff0000, v245
    v_lshlrev_b32 v224, 16, v246
    v_and_b32 v225, 0xffff0000, v246
    v_lshlrev_b32 v226, 16, v247
    v_and_b32 v227, 0xffff0000, v247
    v_lshlrev_b32 v220, 16, v240
    v_and_b32 v221, 0xffff0000, v240
    v_pk_mul_f32 v[236:237], v[236:237], v[4:5]
    v_pk_mul_f32 v[238:239], v[238:239], v[4:5]
    v_pk_mul_f32 v[232:233], v[232:233], v[4:5]
    v_pk_mul_f32 v[234:235], v[234:235], v[4:5]
    v_pk_mul_f32 v[228:229], v[228:229], v[4:5]
    v_pk_mul_f32 v[230:231], v[230:231], v[4:5]
    v_pk_mul_f32 v[224:225], v[224:225], v[4:5]
    v_pk_mul_f32 v[226:227], v[226:227], v[4:5]
    v_pk_mul_f32 v[220:221], v[220:221], v[4:5]
    v_cvt_pk_bf16_f32 v248, v236, v237
    ds_write_b16 v11, v248 offset:17408
    ds_write_b16_d16_hi v11, v248 offset:17424
    v_cvt_pk_bf16_f32 v249, v238, v239
    ds_write_b16 v11, v249 offset:18432
    ds_write_b16_d16_hi v11, v249 offset:18448
    v_cvt_pk_bf16_f32 v250, v232, v233
    ds_write_b16 v11, v250 offset:19456
    ds_write_b16_d16_hi v11, v250 offset:19472
    v_cvt_pk_bf16_f32 v251, v234, v235
    ds_write_b16 v11, v251 offset:20480
    ds_write_b16_d16_hi v11, v251 offset:20496
    v_cvt_pk_bf16_f32 v244, v228, v229
    ds_write_b16 v11, v244 offset:21504
    ds_write_b16_d16_hi v11, v244 offset:21520
    v_cvt_pk_bf16_f32 v245, v230, v231
    ds_write_b16 v11, v245 offset:22528
    ds_write_b16_d16_hi v11, v245 offset:22544
    v_cvt_pk_bf16_f32 v246, v224, v225
    ds_write_b16 v11, v246 offset:23552
    ds_write_b16_d16_hi v11, v246 offset:23568
    v_cvt_pk_bf16_f32 v247, v226, v227
    ds_write_b16 v11, v247 offset:24576
    ds_write_b16_d16_hi v11, v247 offset:24592
    v_cvt_pk_bf16_f32 v240, v220, v221
    ds_write_b16 v11, v240 offset:25600
    ds_write_b16_d16_hi v11, v240 offset:25616
    v_mov_b32 v4, 1
    s_mov_b64 exec, 1
    s_waitcnt lgkmcnt(0)
    ds_add_u32 v253, v4 offset:36
    s_mov_b64 exec, -1
    s_mov_b32 s11, 400000
L_go:
    ds_read_b32 v4, v253 offset:12
    s_waitcnt lgkmcnt(0)
    v_cmp_le_u32 vcc, 3, v4
    s_nop 0
    s_cmp_eq_u64 vcc, exec
    s_cbranch_scc1 L_go_ok
    s_sub_u32 s11, s11, 1
    s_cmp_lg_u32 s11, 0
    s_cbranch_scc1 L_go
L_go_ok:
    s_cmp_ge_u32 s2, 208
    s_cselect_b64 vcc, -1, 0
    s_add_u32 s10, s14, 8192
    buffer_load_dwordx4 v[40:43], v1, s[40:43], s10 offen nt
    s_add_u32 s10, s14, 4096
    buffer_load_dwordx4 v[44:47], v1, s[40:43], s10 offen nt
    s_add_u32 s10, s14, 12288
    buffer_load_dwordx4 v[48:51], v1, s[40:43], s10 offen nt
    s_cbranch_vccz L_fr4
    s_waitcnt vmcnt(3)
L_fr4:
    s_add_u32 s10, s14, 16384
    buffer_load_dwordx4 v[52:55], v1, s[40:43], s10 offen nt
    s_waitcnt vmcnt(4)
    s_cbranch_vccz L_fr5
    s_waitcnt vmcnt(3)
L_fr5:
    s_add_u32 s10, s14, 24576
    buffer_load_dwordx4 v[56:59], v1, s[40:43], s10 offen nt
    s_waitcnt vmcnt(4)
    s_cbranch_vccz L_fr6
    s_waitcnt vmcnt(3)
L_fr6:
    s_add_u32 s10, s14, 20480
    buffer_load_dwordx4 v[60:63], v1, s[40:43], s10 offen nt
    s_waitcnt vmcnt(4)
    s_cbranch_vccz L_fr7
    s_waitcnt vmcnt(3)
L_fr7:
    s_add_u32 s10, s14, 28672
    buffer_load_dwordx4 v[64:67], v1, s[40:43], s10 offen nt
    s_waitcnt vmcnt(4)
    s_cbranch_vccz L_fr8
    s_waitcnt vmcnt(3)
L_fr8:
    s_add_u32 s10, s14, 32768
    buffer_load_dwordx4 v[68:71], v1, s[40:43], s10 offen nt
    s_waitcnt vmcnt(4)
    s_cbranch_vccz L_fr9
    s_waitcnt vmcnt(3)
L_fr9:
    s_add_u32 s10, s14, 40960
    buffer_load_dwordx4 v[72:75], v1, s[40:43], s10 offen nt
    s_waitcnt vmcnt(4)
    s_cbranch_vccz L_fr10
    s_waitcnt vmcnt(3)
L_fr10:
    s_add_u32 s10, s14, 36864
    buffer_load_dwordx4 v[76:79], v1, s[40:43], s10 offen nt
    s_waitcnt vmcnt(4)
    s_cbranch_vccz L_fr11
    s_waitcnt vmcnt(3)
L_fr11:
    s_add_u32 s10, s14, 45056
    buffer_load_dwordx4 v[80:83], v1, s[40:43], s10 offen nt
    s_waitcnt vmcnt(4)
    s_cbranch_vccz L_fr12
    s_waitcnt vmcnt(3)
L_fr12:
    s_add_u32 s10, s14, 49152
    buffer_load_dwordx4 v[84:87], v1, s[40:43], s10 offen nt
    s_waitcnt vmcnt(4)
    s_cbranch_vccz L_fr13
    s_waitcnt vmcnt(3)
L_fr13:
    s_add_u32 s10, s14, 57344
    buffer_load_dwordx4 v[88:91], v1, s[40:43], s10 offen nt
    s_waitcnt vmcnt(4)
    s_cbranch_vccz L_fr14
    s_waitcnt vmcnt(3)
L_fr14:
    s_add_u32 s10, s14, 53248
    buffer_load_dwordx4 v[92:95], v1, s[40:43], s10 offen nt
    s_waitcnt vmcnt(4)
    s_cbranch_vccz L_fr15
    s_waitcnt vmcnt(3)
L_fr15:
    s_add_u32 s10, s14, 61440
    buffer_load_dwordx4 v[96:99], v1, s[40:43], s10 offen nt
    s_cbranch_vccz L_fr16
    s_waitcnt vmcnt(3)
L_fr16:
    s_cmp_ge_i32 s27, 48
    s_cbranch_scc1 L_hi16
    s_waitcnt vmcnt(4)
    s_cmp_ge_i32 s27, -48
    s_cbranch_scc1 L_hi16
    s_waitcnt vmcnt(3)
L_hi16:
    s_add_u32 s10, s14, 131072
    buffer_load_dwordx4 v[100:103], v1, s[40:43], s10 offen nt
    v_mov_b32 v254, 16
    ds_write_b32 v8, v254 offset:16384
    ds_read_b32 v252, v253 offset:4
    s_cbranch_vccz L_fr17
    s_waitcnt vmcnt(3)
L_fr17:
    s_waitcnt lgkmcnt(0)
    v_readfirstlane_b32 s27, v252
    s_nop 0
    s_cmp_ge_i32 s27, 128
    s_cbranch_scc1 L_hi17
    s_waitcnt vmcnt(5)
    s_cmp_ge_i32 s27, 48
    s_cbranch_scc1 L_hi17
    s_waitcnt vmcnt(4)
    s_cmp_ge_i32 s27, -48
    s_cbranch_scc1 L_hi17
    s_waitcnt vmcnt(3)
L_hi17:
    s_add_u32 s10, s14, 139264
    buffer_load_dwordx4 v[104:107], v1, s[40:43], s10 offen nt
    v_mov_b32 v254, 17
    ds_write_b32 v8, v254 offset:16384
    s_waitcnt vmcnt(6)
    s_cbranch_vccz L_fr18
    s_waitcnt vmcnt(3)
L_fr18:
    s_cmp_ge_i32 s27, 128
    s_cbranch_scc1 L_hi18
    s_waitcnt vmcnt(5)
    s_cmp_ge_i32 s27, 48
    s_cbranch_scc1 L_hi18
    s_waitcnt vmcnt(4)
    s_cmp_ge_i32 s27, -48
    s_cbranch_scc1 L_hi18
    s_waitcnt vmcnt(3)
L_hi18:
    s_add_u32 s10, s14, 135168
    buffer_load_dwordx4 v[108:111], v1, s[40:43], s10 offen nt
    v_mov_b32 v254, 18
    ds_write_b32 v8, v254 offset:16384
    ds_read_b32 v252, v253 offset:4
    s_waitcnt vmcnt(6)
    s_cbranch_vccz L_fr19
    s_waitcnt vmcnt(3)
L_fr19:
    s_waitcnt lgkmcnt(0)
    v_readfirstlane_b32 s27, v252
    s_nop 0
    s_cmp_ge_i32 s27, 128
    s_cbranch_scc1 L_hi19
    s_waitcnt vmcnt(5)
    s_cmp_ge_i32 s27, 48
    s_cbranch_scc1 L_hi19
    s_waitcnt vmcnt(4)
    s_cmp_ge_i32 s27, -48
    s_cbranch_scc1 L_hi19
    s_waitcnt vmcnt(3)
L_hi19:
    s_add_u32 s10, s14, 143360
    buffer_load_dwordx4 v[112:115], v1, s[40:43], s10 offen nt
    v_mov_b32 v254, 19
    ds_write_b32 v8, v254 offset:16384
    s_waitcnt vmcnt(6)
    s_cbranch_vccz L_fr20
    s_waitcnt vmcnt(3)
L_fr20:
    s_cmp_ge_i32 s27, 128
    s_cbranch_scc1 L_hi20
    s_waitcnt vmcnt(5)
    s_cmp_ge_i32 s27, 48
    s_cbranch_scc1 L_hi20
    s_waitcnt vmcnt(4)
    s_cmp_ge_i32 s27, -48
    s_cbranch_scc1 L_hi20
    s_waitcnt vmcnt(3)
L_hi20:
    s_add_u32 s10, s14, 147456
    buffer_load_dwordx4 v[116:119], v1, s[40:43], s10 offen nt
    v_mov_b32 v254, 20
    ds_write_b32 v8, v254 offset:16384
    ds_read_b32 v252, v253 offset:4
    s_waitcnt vmcnt(6)
    s_cbranch_vccz L_fr21
    s_waitcnt vmcnt(3)
L_fr21:
    s_waitcnt lgkmcnt(0)
    v_readfirstlane_b32 s27, v252
    s_nop 0
    s_cmp_ge_i32 s27, 128
    s_cbranch_scc1 L_hi21
    s_waitcnt vmcnt(5)
    s_cmp_ge_i32 s27, 48
    s_cbranch_scc1 L_hi21
    s_waitcnt vmcnt(4)
    s_cmp_ge_i32 s27, -48
    s_cbranch_scc1 L_hi21
    s_waitcnt vmcnt(3)
L_hi21:
    s_add_u32 s10, s14, 155648
    buffer_load_dwordx4 v[120:123], v1, s[40:43], s10 offen nt
    v_mov_b32 v254, 21
    ds_write_b32 v8, v254 offset:16384
    s_waitcnt vmcnt(6)
    s_cbranch_vccz L_fr22
    s_waitcnt vmcnt(3)
L_fr22:
    s_cmp_ge_i32 s27, 128
    s_cbranch_scc1 L_hi22
    s_waitcnt vmcnt(5)
    s_cmp_ge_i32 s27, 48
    s_cbranch_scc1 L_hi22
    s_waitcnt vmcnt(4)
    s_cmp_ge_i32 s27, -48
    s_cbranch_scc1 L_hi22
    s_waitcnt vmcnt(3)
L_hi22:
    s_add_u32 s10, s14, 151552
    buffer_load_dwordx4 v[124:127], v1, s[40:43], s10 offen nt
    v_mov_b32 v254, 22
    ds_write_b32 v8, v254 offset:16384
    ds_read_b32 v252, v253 offset:4
    s_waitcnt vmcnt(6)
    s_cbranch_vccz L_fr23
    s_waitcnt vmcnt(3)
L_fr23:
    s_waitcnt lgkmcnt(0)
    v_readfirstlane_b32 s27, v252
    s_nop 0
    s_cmp_ge_i32 s27, 128
    s_cbranch_scc1 L_hi23
    s_waitcnt vmcnt(5)
    s_cmp_ge_i32 s27, 48
    s_cbranch_scc1 L_hi23
    s_waitcnt vmcnt(4)
    s_cmp_ge_i32 s27, -48
    s_cbranch_scc1 L_hi23
    s_waitcnt vmcnt(3)
L_hi23:
    s_add_u32 s10, s14, 159744
    buffer_load_dwordx4 v[128:131], v1, s[40:43], s10 offen nt
    v_mov_b32 v254, 23
    ds_write_b32 v8, v254 offset:16384
    s_waitcnt vmcnt(6)
    s_cbranch_vccz L_fr24
    s_waitcnt vmcnt(3)
L_fr24:
    s_cmp_ge_i32 s27, 128
    s_cbranch_scc1 L_hi24
    s_waitcnt vmcnt(5)
    s_cmp_ge_i32 s27, 48
    s_cbranch_scc1 L_hi24
    s_waitcnt vmcnt(4)
    s_cmp_ge_i32 s27, -48
    s_cbranch_scc1 L_hi24
    s_waitcnt vmcnt(3)
L_hi24:
    s_add_u32 s10, s14, 163840
    buffer_load_dwordx4 v[132:135], v1, s[40:43], s10 offen nt
    v_mov_b32 v254, 24
    ds_write_b32 v8, v254 offset:16384
    ds_read_b32 v252, v253 offset:4
    s_waitcnt vmcnt(6)
    s_cbranch_vccz L_fr25
    s_waitcnt vmcnt(3)
L_fr25:
    s_waitcnt lgkmcnt(0)
    v_readfirstlane_b32 s27, v252
    s_nop 0
    s_cmp_ge_i32 s27, 128
    s_cbranch_scc1 L_hi25
    s_waitcnt vmcnt(5)
    s_cmp_ge_i32 s27, 48
    s_cbranch_scc1 L_hi25
    s_waitcnt vmcnt(4)
    s_cmp_ge_i32 s27, -48
    s_cbranch_scc1 L_hi25
    s_waitcnt vmcnt(3)
L_hi25:
    s_add_u32 s10, s14, 172032
    buffer_load_dwordx4 v[136:139], v1, s[40:43], s10 offen nt
    v_mov_b32 v254, 25
    ds_write_b32 v8, v254 offset:16384
    s_waitcnt vmcnt(6)
    s_cbranch_vccz L_fr26
    s_waitcnt vmcnt(3)
L_fr26:
    s_cmp_ge_i32 s27, 128
    s_cbranch_scc1 L_hi26
    s_waitcnt vmcnt(5)
    s_cmp_ge_i32 s27, 48
    s_cbranch_scc1 L_hi26
    s_waitcnt vmcnt(4)
    s_cmp_ge_i32 s27, -48
    s_cbranch_scc1 L_hi26
    s_waitcnt vmcnt(3)
L_hi26:
    s_add_u32 s10, s14, 167936
    buffer_load_dwordx4 v[140:143], v1, s[40:43], s10 offen nt
    v_mov_b32 v254, 26
    ds_write_b32 v8, v254 offset:16384
    ds_read_b32 v252, v253 offset:4
    s_waitcnt vmcnt(6)
    s_cbranch_vccz L_fr27
    s_waitcnt vmcnt(3)
L_fr27:
    s_waitcnt lgkmcnt(0)
    v_readfirstlane_b32 s27, v252
    s_nop 0
    s_cmp_ge_i32 s27, 128
    s_cbranch_scc1 L_hi27
    s_waitcnt vmcnt(5)
    s_cmp_ge_i32 s27, 48
    s_cbranch_scc1 L_hi27
    s_waitcnt vmcnt(4)
    s_cmp_ge_i32 s27, -48
    s_cbranch_scc1 L_hi27
    s_waitcnt vmcnt(3)
L_hi27:
    s_add_u32 s10, s14, 176128
    buffer_load_dwordx4 v[144:147], v1, s[40:43], s10 offen nt
    v_mov_b32 v254, 27
    ds_write_b32 v8, v254 offset:16384
    s_waitcnt vmcnt(6)
    s_cbranch_vccz L_fr28
    s_waitcnt vmcnt(3)
L_fr28:
    s_cmp_ge_i32 s27, 128
    s_cbranch_scc1 L_hi28
    s_waitcnt vmcnt(5)
    s_cmp_ge_i32 s27, 48
    s_cbranch_scc1 L_hi28
    s_waitcnt vmcnt(4)
    s_cmp_ge_i32 s27, -48
    s_cbranch_scc1 L_hi28
    s_waitcnt vmcnt(3)
L_hi28:
    s_add_u32 s10, s14, 180224
    buffer_load_dwordx4 v[148:151], v1, s[40:43], s10 offen nt
    v_mov_b32 v254, 28
    ds_write_b32 v8, v254 offset:16384
    ds_read_b32 v252, v253 offset:4
    s_waitcnt vmcnt(6)
    s_cbranch_vccz L_fr29
    s_waitcnt vmcnt(3)
L_fr29:
    s_waitcnt lgkmcnt(0)
    v_readfirstlane_b32 s27, v252
    s_nop 0
    s_cmp_ge_i32 s27, 128
    s_cbranch_scc1 L_hi29
    s_waitcnt vmcnt(5)
    s_cmp_ge_i32 s27, 48
    s_cbranch_scc1 L_hi29
    s_waitcnt vmcnt(4)
    s_cmp_ge_i32 s27, -48
    s_cbranch_scc1 L_hi29
    s_waitcnt vmcnt(3)
L_hi29:
    s_add_u32 s10, s14, 188416
    buffer_load_dwordx4 v[152:155], v1, s[40:43], s10 offen nt
    v_mov_b32 v254, 29
    ds_write_b32 v8, v254 offset:16384
    s_waitcnt vmcnt(6)
    s_cbranch_vccz L_fr30
    s_waitcnt vmcnt(3)
L_fr30:
    s_cmp_ge_i32 s27, 128
    s_cbranch_scc1 L_hi30
    s_waitcnt vmcnt(5)
    s_cmp_ge_i32 s27, 48
    s_cbranch_scc1 L_hi30
    s_waitcnt vmcnt(4)
    s_cmp_ge_i32 s27, -48
    s_cbranch_scc1 L_hi30
    s_waitcnt vmcnt(3)
L_hi30:
    s_add_u32 s10, s14, 184320
    buffer_load_dwordx4 v[156:159], v1, s[40:43], s10 offen nt
    v_mov_b32 v254, 30
    ds_write_b32 v8, v254 offset:16384
    ds_read_b32 v252, v253 offset:4
    s_waitcnt vmcnt(6)
    s_cbranch_vccz L_fr31
    s_waitcnt vmcnt(3)
L_fr31:
    s_waitcnt lgkmcnt(0)
    v_readfirstlane_b32 s27, v252
    s_nop 0
    s_cmp_ge_i32 s27, 128
    s_cbranch_scc1 L_hi31
    s_waitcnt vmcnt(5)
    s_cmp_ge_i32 s27, 48
    s_cbranch_scc1 L_hi31
    s_waitcnt vmcnt(4)
    s_cmp_ge_i32 s27, -48
    s_cbranch_scc1 L_hi31
    s_waitcnt vmcnt(3)
L_hi31:
    s_add_u32 s10, s14, 192512
    buffer_load_dwordx4 v[160:163], v1, s[40:43], s10 offen nt
    v_mov_b32 v254, 31
    ds_write_b32 v8, v254 offset:16384
    s_waitcnt vmcnt(6)
    s_cmp_ge_i32 s27, 128
    s_cbranch_scc1 L_hi32
    s_waitcnt vmcnt(5)
    s_cmp_ge_i32 s27, 48
    s_cbranch_scc1 L_hi32
    s_waitcnt vmcnt(4)
    s_cmp_ge_i32 s27, -48
    s_cbranch_scc1 L_hi32
    s_waitcnt vmcnt(3)
L_hi32:
    s_add_u32 s10, s14, 262144
    buffer_load_dwordx4 v[164:167], v1, s[40:43], s10 offen nt
    v_mov_b32 v254, 32
    ds_write_b32 v8, v254 offset:16384
    ds_read_b32 v252, v253 offset:4
    s_waitcnt vmcnt(6)
    s_waitcnt lgkmcnt(0)
    v_readfirstlane_b32 s27, v252
    s_nop 0
    s_cmp_ge_i32 s27, 128
    s_cbranch_scc1 L_hi33
    s_waitcnt vmcnt(5)
    s_cmp_ge_i32 s27, 48
    s_cbranch_scc1 L_hi33
    s_waitcnt vmcnt(4)
    s_cmp_ge_i32 s27, -48
    s_cbranch_scc1 L_hi33
    s_waitcnt vmcnt(3)
L_hi33:
    s_add_u32 s10, s14, 270336
    buffer_load_dwordx4 v[168:171], v1, s[40:43], s10 offen nt
    v_mov_b32 v254, 33
    ds_write_b32 v8, v254 offset:16384
    s_waitcnt vmcnt(6)
    s_cmp_ge_i32 s27, 128
    s_cbranch_scc1 L_hi34
    s_waitcnt vmcnt(5)
    s_cmp_ge_i32 s27, 48
    s_cbranch_scc1 L_hi34
    s_waitcnt vmcnt(4)
    s_cmp_ge_i32 s27, -48
    s_cbranch_scc1 L_hi34
    s_waitcnt vmcnt(3)
L_hi34:
    s_add_u32 s10, s14, 266240
    buffer_load_dwordx4 v[172:175], v1, s[40:43], s10 offen nt
    v_mov_b32 v254, 34
    ds_write_b32 v8, v254 offset:16384
    ds_read_b32 v252, v253 offset:4
    s_waitcnt vmcnt(6)
    s_waitcnt lgkmcnt(0)
    v_readfirstlane_b32 s27, v252
    s_nop 0
    s_cmp_ge_i32 s27, 128
    s_cbranch_scc1 L_hi35
    s_waitcnt vmcnt(5)
    s_cmp_ge_i32 s27, 48
    s_cbranch_scc1 L_hi35
    s_waitcnt vmcnt(4)
    s_cmp_ge_i32 s27, -48
    s_cbranch_scc1 L_hi35
    s_waitcnt vmcnt(3)
L_hi35:
    s_add_u32 s10, s14, 274432
    buffer_load_dwordx4 v[176:179], v1, s[40:43], s10 offen nt
    v_mov_b32 v254, 35
    ds_write_b32 v8, v254 offset:16384
    s_waitcnt vmcnt(6)
    s_cmp_ge_i32 s27, 128
    s_cbranch_scc1 L_hi36
    s_waitcnt vmcnt(5)
    s_cmp_ge_i32 s27, 48
    s_cbranch_scc1 L_hi36
    s_waitcnt vmcnt(4)
    s_cmp_ge_i32 s27, -48
    s_cbranch_scc1 L_hi36
    s_waitcnt vmcnt(3)
L_hi36:
    s_add_u32 s10, s14, 278528
    buffer_load_dwordx4 v[180:183], v1, s[40:43], s10 offen nt
    v_mov_b32 v254, 36
    ds_write_b32 v8, v254 offset:16384
    ds_read_b32 v252, v253 offset:4
    s_waitcnt vmcnt(6)
    s_waitcnt lgkmcnt(0)
    v_readfirstlane_b32 s27, v252
    s_nop 0
    s_cmp_ge_i32 s27, 128
    s_cbranch_scc1 L_hi37
    s_waitcnt vmcnt(5)
    s_cmp_ge_i32 s27, 48
    s_cbranch_scc1 L_hi37
    s_waitcnt vmcnt(4)
    s_cmp_ge_i32 s27, -48
    s_cbranch_scc1 L_hi37
    s_waitcnt vmcnt(3)
L_hi37:
    s_add_u32 s10, s14, 286720
    buffer_load_dwordx4 v[184:187], v1, s[40:43], s10 offen nt
    v_mov_b32 v254, 37
    ds_write_b32 v8, v254 offset:16384
    s_waitcnt vmcnt(6)
    s_cmp_ge_i32 s27, 128
    s_cbranch_scc1 L_hi38
    s_waitcnt vmcnt(5)
    s_cmp_ge_i32 s27, 48
    s_cbranch_scc1 L_hi38
    s_waitcnt vmcnt(4)
    s_cmp_ge_i32 s27, -48
    s_cbranch_scc1 L_hi38
    s_waitcnt vmcnt(3)
L_hi38:
    s_add_u32 s10, s14, 282624
    buffer_load_dwordx4 v[188:191], v1, s[40:43], s10 offen nt
    v_mov_b32 v254, 38
    ds_write_b32 v8, v254 offset:16384
    ds_read_b32 v252, v253 offset:4
    s_waitcnt vmcnt(6)
    s_waitcnt lgkmcnt(0)
    v_readfirstlane_b32 s27, v252
    s_nop 0
    s_cmp_ge_i32 s27, 128
    s_cbranch_scc1 L_hi39
    s_waitcnt vmcnt(5)
    s_cmp_ge_i32 s27, 48
    s_cbranch_scc1 L_hi39
    s_waitcnt vmcnt(4)
    s_cmp_ge_i32 s27, -48
    s_cbranch_scc1 L_hi39
    s_waitcnt vmcnt(3)
L_hi39:
    s_add_u32 s10, s14, 290816
    buffer_load_dwordx4 v[192:195], v1, s[40:43], s10 offen nt
    v_mov_b32 v254, 39
    ds_write_b32 v8, v254 offset:16384
    s_waitcnt vmcnt(6)
    s_cmp_ge_i32 s27, 128
    s_cbranch_scc1 L_hi40
    s_waitcnt vmcnt(5)
    s_cmp_ge_i32 s27, 48
    s_cbranch_scc1 L_hi40
    s_waitcnt vmcnt(4)
    s_cmp_ge_i32 s27, -48
    s_cbranch_scc1 L_hi40
    s_waitcnt vmcnt(3)
L_hi40:
    s_add_u32 s10, s14, 294912
    buffer_load_dwordx4 v[196:199], v1, s[40:43], s10 offen nt
    v_mov_b32 v254, 40
    ds_write_b32 v8, v254 offset:16384
    ds_read_b32 v252, v253 offset:4
    s_waitcnt vmcnt(6)
    s_waitcnt lgkmcnt(0)
    v_readfirstlane_b32 s27, v252
    s_nop 0
    s_cmp_ge_i32 s27, 128
    s_cbranch_scc1 L_hi41
    s_waitcnt vmcnt(5)
    s_cmp_ge_i32 s27, 48
    s_cbranch_scc1 L_hi41
    s_waitcnt vmcnt(4)
    s_cmp_ge_i32 s27, -48
    s_cbranch_scc1 L_hi41
    s_waitcnt vmcnt(3)
L_hi41:
    s_add_u32 s10, s14, 303104
    buffer_load_dwordx4 v[200:203], v1, s[40:43], s10 offen nt
    v_mov_b32 v254, 41
    ds_write_b32 v8, v254 offset:16384
    s_waitcnt vmcnt(6)
    s_cmp_ge_i32 s27, 128
    s_cbranch_scc1 L_hi42
    s_waitcnt vmcnt(5)
    s_cmp_ge_i32 s27, 48
    s_cbranch_scc1 L_hi42
    s_waitcnt vmcnt(4)
    s_cmp_ge_i32 s27, -48
    s_cbranch_scc1 L_hi42
    s_waitcnt vmcnt(3)
L_hi42:
    s_add_u32 s10, s14, 299008
    buffer_load_dwordx4 v[204:207], v1, s[40:43], s10 offen nt
    v_mov_b32 v254, 42
    ds_write_b32 v8, v254 offset:16384
    ds_read_b32 v252, v253 offset:4
    s_waitcnt vmcnt(6)
    s_waitcnt lgkmcnt(0)
    v_readfirstlane_b32 s27, v252
    s_nop 0
    s_cmp_ge_i32 s27, 128
    s_cbranch_scc1 L_hi43
    s_waitcnt vmcnt(5)
    s_cmp_ge_i32 s27, 48
    s_cbranch_scc1 L_hi43
    s_waitcnt vmcnt(4)
    s_cmp_ge_i32 s27, -48
    s_cbranch_scc1 L_hi43
    s_waitcnt vmcnt(3)
L_hi43:
    s_add_u32 s10, s14, 307200
    buffer_load_dwordx4 v[208:211], v1, s[40:43], s10 offen nt
    v_mov_b32 v254, 43
    ds_write_b32 v8, v254 offset:16384
    s_waitcnt vmcnt(6)
    s_cmp_ge_i32 s27, 128
    s_cbranch_scc1 L_hi44
    s_waitcnt vmcnt(5)
    s_cmp_ge_i32 s27, 48
    s_cbranch_scc1 L_hi44
    s_waitcnt vmcnt(4)
    s_cmp_ge_i32 s27, -48
    s_cbranch_scc1 L_hi44
    s_waitcnt vmcnt(3)
L_hi44:
    s_add_u32 s10, s14, 311296
    buffer_load_dwordx4 v[212:215], v1, s[40:43], s10 offen nt
    v_mov_b32 v254, 44
    ds_write_b32 v8, v254 offset:16384
    ds_read_b32 v252, v253 offset:4
    s_waitcnt vmcnt(6)
    s_waitcnt lgkmcnt(0)
    v_readfirstlane_b32 s27, v252
    s_nop 0
    s_cmp_ge_i32 s27, 128
    s_cbranch_scc1 L_hi45
    s_waitcnt vmcnt(5)
    s_cmp_ge_i32 s27, 48
    s_cbranch_scc1 L_hi45
    s_waitcnt vmcnt(4)
    s_cmp_ge_i32 s27, -48
    s_cbranch_scc1 L_hi45
    s_waitcnt vmcnt(3)
L_hi45:
    s_add_u32 s10, s14, 319488
    buffer_load_dwordx4 v[216:219], v1, s[40:43], s10 offen nt
    v_mov_b32 v254, 45
    ds_write_b32 v8, v254 offset:16384
    s_waitcnt vmcnt(6)
    s_cmp_ge_i32 s27, 128
    s_cbranch_scc1 L_hi46
    s_waitcnt vmcnt(5)
    s_cmp_ge_i32 s27, 48
    s_cbranch_scc1 L_hi46
    s_waitcnt vmcnt(4)
    s_cmp_ge_i32 s27, -48
    s_cbranch_scc1 L_hi46
    s_waitcnt vmcnt(3)
L_hi46:
    s_add_u32 s10, s14, 315392
    buffer_load_dwordx4 v[220:223], v1, s[40:43], s10 offen nt
    v_mov_b32 v254, 46
    ds_write_b32 v8, v254 offset:16384
    ds_read_b32 v252, v253 offset:4
    s_waitcnt vmcnt(6)
    s_waitcnt lgkmcnt(0)
    v_readfirstlane_b32 s27, v252
    s_nop 0
    s_cmp_ge_i32 s27, 128
    s_cbranch_scc1 L_hi47
    s_waitcnt vmcnt(5)
    s_cmp_ge_i32 s27, 48
    s_cbranch_scc1 L_hi47
    s_waitcnt vmcnt(4)
    s_cmp_ge_i32 s27, -48
    s_cbranch_scc1 L_hi47
    s_waitcnt vmcnt(3)
L_hi47:
    s_add_u32 s10, s14, 323584
    buffer_load_dwordx4 v[224:227], v1, s[40:43], s10 offen nt
    v_mov_b32 v254, 47
    ds_write_b32 v8, v254 offset:16384
    s_waitcnt vmcnt(6)
    s_cmp_ge_i32 s27, 128
    s_cbranch_scc1 L_hi48
    s_waitcnt vmcnt(5)
    s_cmp_ge_i32 s27, 48
    s_cbranch_scc1 L_hi48
    s_waitcnt vmcnt(4)
    s_cmp_ge_i32 s27, -48
    s_cbranch_scc1 L_hi48
    s_waitcnt vmcnt(3)
L_hi48:
    s_add_u32 s10, s14, 393216
    buffer_load_dwordx4 v[228:231], v1, s[40:43], s10 offen nt
    v_mov_b32 v254, 48
    ds_write_b32 v8, v254 offset:16384
    ds_read_b32 v252, v253 offset:4
    s_waitcnt vmcnt(6)
    s_waitcnt lgkmcnt(0)
    v_readfirstlane_b32 s27, v252
    s_nop 0
    s_cmp_ge_i32 s27, 128
    s_cbranch_scc1 L_hi49
    s_waitcnt vmcnt(5)
    s_cmp_ge_i32 s27, 48
    s_cbranch_scc1 L_hi49
    s_waitcnt vmcnt(4)
    s_cmp_ge_i32 s27, -48
    s_cbranch_scc1 L_hi49
    s_waitcnt vmcnt(3)
L_hi49:
    s_add_u32 s10, s14, 401408
    buffer_load_dwordx4 v[232:235], v1, s[40:43], s10 offen nt
    v_mov_b32 v254, 49
    ds_write_b32 v8, v254 offset:16384
    ds_read_b32 v10, v253 offset:8
    ds_read_b128 v[16:19], v9 offset:1024
    ds_read_b32 v4, v253 offset:0
    s_waitcnt vmcnt(6)
    s_cmp_ge_i32 s27, 128
    s_cbranch_scc1 L_hi50
    s_waitcnt vmcnt(5)
    s_cmp_ge_i32 s27, 48
    s_cbranch_scc1 L_hi50
    s_waitcnt vmcnt(4)
    s_cmp_ge_i32 s27, -48
    s_cbranch_scc1 L_hi50
    s_waitcnt vmcnt(3)
L_hi50:
    s_add_u32 s10, s14, 397312
    buffer_load_dwordx4 v[236:239], v1, s[40:43], s10 offen nt
    v_mov_b32 v254, 50
    ds_write_b32 v8, v254 offset:16384
    ds_read_b32 v252, v253 offset:4
    s_waitcnt vmcnt(6)
    s_waitcnt lgkmcnt(0)
    v_readfirstlane_b32 s27, v252
    s_nop 0
    s_cmp_ge_i32 s27, 128
    s_cbranch_scc1 L_hi51
    s_waitcnt vmcnt(5)
    s_cmp_ge_i32 s27, 48
    s_cbranch_scc1 L_hi51
    s_waitcnt vmcnt(4)
    s_cmp_ge_i32 s27, -48
    s_cbranch_scc1 L_hi51
    s_waitcnt vmcnt(3)
L_hi51:
    s_add_u32 s10, s14, 405504
    buffer_load_dwordx4 v[240:243], v1, s[40:43], s10 offen nt
    v_mov_b32 v254, 51
    ds_write_b32 v8, v254 offset:16384
    v_cmp_ne_u32 vcc, 0, v10
    s_nop 0
    s_cmp_eq_u64 vcc, exec
    s_cbranch_scc1 L_rdy_ok
    s_mov_b32 s11, 400000
L_rdy:
    ds_read_b32 v10, v253 offset:8
    ds_read_b128 v[16:19], v9 offset:1024
    ds_read_b32 v4, v253 offset:0
    s_waitcnt lgkmcnt(0)
    v_cmp_ne_u32 vcc, 0, v10
    s_nop 0
    s_cmp_eq_u64 vcc, exec
    s_cbranch_scc1 L_rdy_ok
    s_sub_u32 s11, s11, 1
    s_cmp_lg_u32 s11, 0
    s_cbranch_scc1 L_rdy
L_rdy_ok:
    v_and_b32 v3, 8, v0
    v_cmp_eq_u32 vcc, 0, v3
    v_mov_b32 v5, 0xff800000
    s_mov_b32 s15, 0x3db504f3
    v_readfirstlane_b32 s100, v4
    s_nop 0
    s_and_b32 s100, s100, 1
    v_cndmask_b32 v20, v16, 0, vcc
    v_cndmask_b32 v21, v17, 0, vcc
    v_cndmask_b32 v22, v18, 0, vcc
    v_cndmask_b32 v23, v19, 0, vcc
    v_cndmask_b32 v16, 0, v16, vcc
    v_cndmask_b32 v17, 0, v17, vcc
    v_cndmask_b32 v18, 0, v18, vcc
    v_cndmask_b32 v19, 0, v19, vcc
    s_nop 1
    v_mfma_f32_16x16x32_bf16 v[28:31], v[36:39], v[16:19], 0
    v_mfma_f32_16x16x32_bf16 v[28:31], v[40:43], v[20:23], v[28:31]
    v_mfma_f32_16x16x32_bf16 v[32:35], v[44:47], v[16:19], 0
    v_mfma_f32_16x16x32_bf16 v[32:35], v[48:51], v[20:23], v[32:35]
    s_waitcnt vmcnt(6)
    s_cmp_ge_i32 s27, 128
    s_cbranch_scc1 L_hi52
    s_waitcnt vmcnt(5)
    s_cmp_ge_i32 s27, 48
    s_cbranch_scc1 L_hi52
    s_waitcnt vmcnt(4)
    s_cmp_ge_i32 s27, -48
    s_cbranch_scc1 L_hi52
    s_waitcnt vmcnt(3)
L_hi52:
    s_add_u32 s10, s14, 409600
    buffer_load_dwordx4 v[36:39], v1, s[40:43], s10 offen nt
    v_mov_b32 v254, 52
    ds_write_b32 v8, v254 offset:16384
    ds_read_b32 v252, v253 offset:4
    s_waitcnt vmcnt(6)
    s_waitcnt lgkmcnt(0)
    v_readfirstlane_b32 s27, v252
    s_nop 0
    s_cmp_ge_i32 s27, 128
    s_cbranch_scc1 L_hi53
    s_waitcnt vmcnt(5)
    s_cmp_ge_i32 s27, 48
    s_cbranch_scc1 L_hi53
    s_waitcnt vmcnt(4)
    s_cmp_ge_i32 s27, -48
    s_cbranch_scc1 L_hi53
    s_waitcnt vmcnt(3)
L_hi53:
    s_add_u32 s10, s14, 417792
    buffer_load_dwordx4 v[40:43], v1, s[40:43], s10 offen nt
    v_mov_b32 v254, 53
    ds_write_b32 v8, v254 offset:16384
    v_mfma_f32_16x16x32_bf16 v[248:251], v[52:55], v[16:19], 0
    v_mfma_f32_16x16x32_bf16 v[248:251], v[56:59], v[20:23], v[248:251]
    v_mfma_f32_16x16x32_bf16 v[244:247], v[60:63], v[16:19], 0
    v_mfma_f32_16x16x32_bf16 v[244:247], v[64:67], v[20:23], v[244:247]
    s_waitcnt vmcnt(6)
    s_cmp_ge_i32 s27, 128
    s_cbranch_scc1 L_hi54
    s_waitcnt vmcnt(5)
    s_cmp_ge_i32 s27, 48
    s_cbranch_scc1 L_hi54
    s_waitcnt vmcnt(4)
    s_cmp_ge_i32 s27, -48
    s_cbranch_scc1 L_hi54
    s_waitcnt vmcnt(3)
L_hi54:
    s_add_u32 s10, s14, 413696
    buffer_load_dwordx4 v[44:47], v1, s[40:43], s10 offen nt
    v_mov_b32 v254, 54
    ds_write_b32 v8, v254 offset:16384
    ds_read_b32 v252, v253 offset:4
    s_waitcnt vmcnt(6)
    s_waitcnt lgkmcnt(0)
    v_readfirstlane_b32 s27, v252
    s_nop 0
    s_cmp_ge_i32 s27, 128
    s_cbranch_scc1 L_hi55
    s_waitcnt vmcnt(5)
    s_cmp_ge_i32 s27, 48
    s_cbranch_scc1 L_hi55
    s_waitcnt vmcnt(4)
    s_cmp_ge_i32 s27, -48
    s_cbranch_scc1 L_hi55
    s_waitcnt vmcnt(3)
L_hi55:
    s_add_u32 s10, s14, 421888
    buffer_load_dwordx4 v[48:51], v1, s[40:43], s10 offen nt
    v_mov_b32 v254, 55
    ds_write_b32 v8, v254 offset:16384
    v_mov_b32_dpp v64, v28 quad_perm:[0,0,0,0] row_mask:0xf bank_mask:0xf
    v_mov_b32_dpp v65, v32 quad_perm:[0,0,0,0] row_mask:0xf bank_mask:0xf
    s_nop 0
    v_add_f32_dpp v64, v29, v64 quad_perm:[1,1,1,1] row_mask:0xf bank_mask:0xf
    v_add_f32_dpp v65, v33, v65 quad_perm:[1,1,1,1] row_mask:0xf bank_mask:0xf
    s_nop 0
    v_add_f32_dpp v64, v30, v64 quad_perm:[2,2,2,2] row_mask:0xf bank_mask:0xf
    v_add_f32_dpp v65, v34, v65 quad_perm:[2,2,2,2] row_mask:0xf bank_mask:0xf
    s_nop 0
    v_add_f32_dpp v64, v31, v64 quad_perm:[3,3,3,3] row_mask:0xf bank_mask:0xf
    v_add_f32_dpp v65, v35, v65 quad_perm:[3,3,3,3] row_mask:0xf bank_mask:0xf
    v_cvt_pk_bf16_f32 v3, v64, v65
    v_lshlrev_b32 v64, 16, v3
    v_and_b32 v65, 0xffff0000, v3
    v_mul_f32 v64, s15, v64
    v_mul_f32 v65, s15, v65
    v_cvt_pk_bf16_f32 v3, v64, v65
    v_lshlrev_b32 v64, 16, v3
    v_and_b32 v65, 0xffff0000, v3
    v_max3_f32 v5, v5, v64, v65
    v_mfma_f32_16x16x32_bf16 v[28:31], v[68:71], v[16:19], 0
    v_mfma_f32_16x16x32_bf16 v[28:31], v[72:75], v[20:23], v[28:31]
    v_mfma_f32_16x16x32_bf16 v[32:35], v[76:79], v[16:19], 0
    v_mfma_f32_16x16x32_bf16 v[32:35], v[80:83], v[20:23], v[32:35]
    s_waitcnt vmcnt(6)
    s_cmp_ge_i32 s27, 128
    s_cbranch_scc1 L_hi56
    s_waitcnt vmcnt(5)
    s_cmp_ge_i32 s27, 48
    s_cbranch_scc1 L_hi56
    s_waitcnt vmcnt(4)
    s_cmp_ge_i32 s27, -48
    s_cbranch_scc1 L_hi56
    s_waitcnt vmcnt(3)
L_hi56:
    s_add_u32 s10, s14, 425984
    buffer_load_dwordx4 v[52:55], v1, s[40:43], s10 offen nt
    v_mov_b32 v254, 56
    ds_write_b32 v8, v254 offset:16384
    ds_read_b32 v252, v253 offset:4
    s_waitcnt vmcnt(6)
    s_waitcnt lgkmcnt(0)
    v_readfirstlane_b32 s27, v252
    s_nop 0
    s_cmp_ge_i32 s27, 128
    s_cbranch_scc1 L_hi57
    s_waitcnt vmcnt(5)
    s_cmp_ge_i32 s27, 48
    s_cbranch_scc1 L_hi57
    s_waitcnt vmcnt(4)
    s_cmp_ge_i32 s27, -48
    s_cbranch_scc1 L_hi57
    s_waitcnt vmcnt(3)
L_hi57:
    s_add_u32 s10, s14, 434176
    buffer_load_dwordx4 v[56:59], v1, s[40:43], s10 offen nt
    v_mov_b32 v254, 57
    ds_write_b32 v8, v254 offset:16384
    v_mov_b32_dpp v66, v248 quad_perm:[0,0,0,0] row_mask:0xf bank_mask:0xf
    v_mov_b32_dpp v67, v244 quad_perm:[0,0,0,0] row_mask:0xf bank_mask:0xf
    s_nop 0
    v_add_f32_dpp v66, v249, v66 quad_perm:[1,1,1,1] row_mask:0xf bank_mask:0xf
    v_add_f32_dpp v67, v245, v67 quad_perm:[1,1,1,1] row_mask:0xf bank_mask:0xf
    s_nop 0
    v_add_f32_dpp v66, v250, v66 quad_perm:[2,2,2,2] row_mask:0xf bank_mask:0xf
    v_add_f32_dpp v67, v246, v67 quad_perm:[2,2,2,2] row_mask:0xf bank_mask:0xf
    s_nop 0
    v_add_f32_dpp v66, v251, v66 quad_perm:[3,3,3,3] row_mask:0xf bank_mask:0xf
    v_add_f32_dpp v67, v247, v67 quad_perm:[3,3,3,3] row_mask:0xf bank_mask:0xf
    v_cvt_pk_bf16_f32 v3, v66, v67
    v_lshlrev_b32 v66, 16, v3
    v_and_b32 v67, 0xffff0000, v3
    v_mul_f32 v66, s15, v66
    v_mul_f32 v67, s15, v67
    v_cvt_pk_bf16_f32 v3, v66, v67
    v_lshlrev_b32 v66, 16, v3
    v_and_b32 v67, 0xffff0000, v3
    v_max3_f32 v5, v5, v66, v67
    v_mfma_f32_16x16x32_bf16 v[248:251], v[84:87], v[16:19], 0
    v_mfma_f32_16x16x32_bf16 v[248:251], v[88:91], v[20:23], v[248:251]
    v_mfma_f32_16x16x32_bf16 v[244:247], v[92:95], v[16:19], 0
    v_mfma_f32_16x16x32_bf16 v[244:247], v[96:99], v[20:23], v[244:247]
    s_waitcnt vmcnt(6)
    s_cmp_ge_i32 s27, 128
    s_cbranch_scc1 L_hi58
    s_waitcnt vmcnt(5)
    s_cmp_ge_i32 s27, 48
    s_cbranch_scc1 L_hi58
    s_waitcnt vmcnt(4)
    s_cmp_ge_i32 s27, -48
    s_cbranch_scc1 L_hi58
    s_waitcnt vmcnt(3)
L_hi58:
    s_add_u32 s10, s14, 430080
    buffer_load_dwordx4 v[60:63], v1, s[40:43], s10 offen nt
    v_mov_b32 v254, 58
    ds_write_b32 v8, v254 offset:16384
    ds_read_b32 v252, v253 offset:4
    s_waitcnt vmcnt(6)
    s_waitcnt lgkmcnt(0)
    v_readfirstlane_b32 s27, v252
    s_nop 0
    s_cmp_ge_i32 s27, 128
    s_cbranch_scc1 L_hi59
    s_waitcnt vmcnt(5)
    s_cmp_ge_i32 s27, 48
    s_cbranch_scc1 L_hi59
    s_waitcnt vmcnt(4)
    s_cmp_ge_i32 s27, -48
    s_cbranch_scc1 L_hi59
    s_waitcnt vmcnt(3)
L_hi59:
    s_add_u32 s10, s14, 438272
    buffer_load_dwordx4 v[68:71], v1, s[40:43], s10 offen nt
    v_mov_b32 v254, 59
    ds_write_b32 v8, v254 offset:16384
    v_mov_b32_dpp v96, v28 quad_perm:[0,0,0,0] row_mask:0xf bank_mask:0xf
    v_mov_b32_dpp v97, v32 quad_perm:[0,0,0,0] row_mask:0xf bank_mask:0xf
    s_nop 0
    v_add_f32_dpp v96, v29, v96 quad_perm:[1,1,1,1] row_mask:0xf bank_mask:0xf
    v_add_f32_dpp v97, v33, v97 quad_perm:[1,1,1,1] row_mask:0xf bank_mask:0xf
    s_nop 0
    v_add_f32_dpp v96, v30, v96 quad_perm:[2,2,2,2] row_mask:0xf bank_mask:0xf
    v_add_f32_dpp v97, v34, v97 quad_perm:[2,2,2,2] row_mask:0xf bank_mask:0xf
    s_nop 0
    v_add_f32_dpp v96, v31, v96 quad_perm:[3,3,3,3] row_mask:0xf bank_mask:0xf
    v_add_f32_dpp v97, v35, v97 quad_perm:[3,3,3,3] row_mask:0xf bank_mask:0xf
    v_cvt_pk_bf16_f32 v3, v96, v97
    v_lshlrev_b32 v96, 16, v3
    v_and_b32 v97, 0xffff0000, v3
    v_mul_f32 v96, s15, v96
    v_mul_f32 v97, s15, v97
    v_cvt_pk_bf16_f32 v3, v96, v97
    v_lshlrev_b32 v96, 16, v3
    v_and_b32 v97, 0xffff0000, v3
    v_max3_f32 v5, v5, v96, v97
    v_mfma_f32_16x16x32_bf16 v[28:31], v[100:103], v[16:19], 0
    v_mfma_f32_16x16x32_bf16 v[28:31], v[104:107], v[20:23], v[28:31]
    v_mfma_f32_16x16x32_bf16 v[32:35], v[108:111], v[16:19], 0
    v_mfma_f32_16x16x32_bf16 v[32:35], v[112:115], v[20:23], v[32:35]
    s_waitcnt vmcnt(6)
    s_cmp_ge_i32 s27, 128
    s_cbranch_scc1 L_hi60
    s_waitcnt vmcnt(5)
    s_cmp_ge_i32 s27, 48
    s_cbranch_scc1 L_hi60
    s_waitcnt vmcnt(4)
    s_cmp_ge_i32 s27, -48
    s_cbranch_scc1 L_hi60
    s_waitcnt vmcnt(3)
L_hi60:
    s_add_u32 s10, s14, 442368
    buffer_load_dwordx4 v[72:75], v1, s[40:43], s10 offen nt
    v_mov_b32 v254, 60
    ds_write_b32 v8, v254 offset:16384
    ds_read_b32 v252, v253 offset:4
    s_waitcnt vmcnt(6)
    s_waitcnt lgkmcnt(0)
    v_readfirstlane_b32 s27, v252
    s_nop 0
    s_cmp_ge_i32 s27, 128
    s_cbranch_scc1 L_hi61
    s_waitcnt vmcnt(5)
    s_cmp_ge_i32 s27, 48
    s_cbranch_scc1 L_hi61
    s_waitcnt vmcnt(4)
    s_cmp_ge_i32 s27, -48
    s_cbranch_scc1 L_hi61
    s_waitcnt vmcnt(3)
L_hi61:
    s_add_u32 s10, s14, 450560
    buffer_load_dwordx4 v[76:79], v1, s[40:43], s10 offen nt
    v_mov_b32 v254, 61
    ds_write_b32 v8, v254 offset:16384
    v_mov_b32_dpp v98, v248 quad_perm:[0,0,0,0] row_mask:0xf bank_mask:0xf
    v_mov_b32_dpp v99, v244 quad_perm:[0,0,0,0] row_mask:0xf bank_mask:0xf
    s_nop 0
    v_add_f32_dpp v98, v249, v98 quad_perm:[1,1,1,1] row_mask:0xf bank_mask:0xf
    v_add_f32_dpp v99, v245, v99 quad_perm:[1,1,1,1] row_mask:0xf bank_mask:0xf
    s_nop 0
    v_add_f32_dpp v98, v250, v98 quad_perm:[2,2,2,2] row_mask:0xf bank_mask:0xf
    v_add_f32_dpp v99, v246, v99 quad_perm:[2,2,2,2] row_mask:0xf bank_mask:0xf
    s_nop 0
    v_add_f32_dpp v98, v251, v98 quad_perm:[3,3,3,3] row_mask:0xf bank_mask:0xf
    v_add_f32_dpp v99, v247, v99 quad_perm:[3,3,3,3] row_mask:0xf bank_mask:0xf
    v_cvt_pk_bf16_f32 v3, v98, v99
    v_lshlrev_b32 v98, 16, v3
    v_and_b32 v99, 0xffff0000, v3
    v_mul_f32 v98, s15, v98
    v_mul_f32 v99, s15, v99
    v_cvt_pk_bf16_f32 v3, v98, v99
    v_lshlrev_b32 v98, 16, v3
    v_and_b32 v99, 0xffff0000, v3
    v_max3_f32 v5, v5, v98, v99
    v_mfma_f32_16x16x32_bf16 v[248:251], v[116:119], v[16:19], 0
    v_mfma_f32_16x16x32_bf16 v[248:251], v[120:123], v[20:23], v[248:251]
    v_mfma_f32_16x16x32_bf16 v[244:247], v[124:127], v[16:19], 0
    v_mfma_f32_16x16x32_bf16 v[244:247], v[128:131], v[20:23], v[244:247]
    s_waitcnt vmcnt(6)
    s_cmp_ge_i32 s27, 128
    s_cbranch_scc1 L_hi62
    s_waitcnt vmcnt(5)
    s_cmp_ge_i32 s27, 48
    s_cbranch_scc1 L_hi62
    s_waitcnt vmcnt(4)
    s_cmp_ge_i32 s27, -48
    s_cbranch_scc1 L_hi62
    s_waitcnt vmcnt(3)
L_hi62:
    s_add_u32 s10, s14, 446464
    buffer_load_dwordx4 v[80:83], v1, s[40:43], s10 offen nt
    v_mov_b32 v254, 62
    ds_write_b32 v8, v254 offset:16384
    ds_read_b32 v252, v253 offset:4
    s_waitcnt vmcnt(6)
    s_waitcnt lgkmcnt(0)
    v_readfirstlane_b32 s27, v252
    s_nop 0
    s_cmp_ge_i32 s27, 128
    s_cbranch_scc1 L_hi63
    s_waitcnt vmcnt(5)
    s_cmp_ge_i32 s27, 48
    s_cbranch_scc1 L_hi63
    s_waitcnt vmcnt(4)
    s_cmp_ge_i32 s27, -48
    s_cbranch_scc1 L_hi63
    s_waitcnt vmcnt(3)
L_hi63:
    s_add_u32 s10, s14, 454656
    buffer_load_dwordx4 v[84:87], v1, s[40:43], s10 offen nt
    v_mov_b32 v254, 63
    ds_write_b32 v8, v254 offset:16384
    v_mov_b32_dpp v128, v28 quad_perm:[0,0,0,0] row_mask:0xf bank_mask:0xf
    v_mov_b32_dpp v129, v32 quad_perm:[0,0,0,0] row_mask:0xf bank_mask:0xf
    s_nop 0
    v_add_f32_dpp v128, v29, v128 quad_perm:[1,1,1,1] row_mask:0xf bank_mask:0xf
    v_add_f32_dpp v129, v33, v129 quad_perm:[1,1,1,1] row_mask:0xf bank_mask:0xf
    s_nop 0
    v_add_f32_dpp v128, v30, v128 quad_perm:[2,2,2,2] row_mask:0xf bank_mask:0xf
    v_add_f32_dpp v129, v34, v129 quad_perm:[2,2,2,2] row_mask:0xf bank_mask:0xf
    s_nop 0
    v_add_f32_dpp v128, v31, v128 quad_perm:[3,3,3,3] row_mask:0xf bank_mask:0xf
    v_add_f32_dpp v129, v35, v129 quad_perm:[3,3,3,3] row_mask:0xf bank_mask:0xf
    v_cvt_pk_bf16_f32 v3, v128, v129
    v_lshlrev_b32 v128, 16, v3
    v_and_b32 v129, 0xffff0000, v3
    v_mul_f32 v128, s15, v128
    v_mul_f32 v129, s15, v129
    v_cvt_pk_bf16_f32 v3, v128, v129
    v_lshlrev_b32 v128, 16, v3
    v_and_b32 v129, 0xffff0000, v3
    v_max3_f32 v5, v5, v128, v129
    v_mfma_f32_16x16x32_bf16 v[28:31], v[132:135], v[16:19], 0
    v_mfma_f32_16x16x32_bf16 v[28:31], v[136:139], v[20:23], v[28:31]
    v_mfma_f32_16x16x32_bf16 v[32:35], v[140:143], v[16:19], 0
    v_mfma_f32_16x16x32_bf16 v[32:35], v[144:147], v[20:23], v[32:35]
    s_waitcnt vmcnt(6)
    s_cmp_ge_i32 s27, 128
    s_cbranch_scc1 L_hi64
    s_waitcnt vmcnt(5)
    s_cmp_ge_i32 s27, 48
    s_cbranch_scc1 L_hi64
    s_waitcnt vmcnt(4)
    s_cmp_ge_i32 s27, -48
    s_cbranch_scc1 L_hi64
    s_waitcnt vmcnt(3)
L_hi64:
    s_add_u32 s10, s14, 0
    buffer_load_dwordx4 v[88:91], v2, s[44:47], s10 offen nt
    v_mov_b32 v254, 64
    ds_write_b32 v8, v254 offset:16384
    ds_read_b32 v252, v253 offset:4
    s_waitcnt vmcnt(6)
    s_waitcnt lgkmcnt(0)
    v_readfirstlane_b32 s27, v252
    s_nop 0
    s_cmp_ge_i32 s27, 128
    s_cbranch_scc1 L_hi65
    s_waitcnt vmcnt(5)
    s_cmp_ge_i32 s27, 48
    s_cbranch_scc1 L_hi65
    s_waitcnt vmcnt(4)
    s_cmp_ge_i32 s27, -48
    s_cbranch_scc1 L_hi65
    s_waitcnt vmcnt(3)
L_hi65:
    s_add_u32 s10, s14, 8192
    buffer_load_dwordx4 v[92:95], v2, s[44:47], s10 offen nt
    v_mov_b32 v254, 65
    ds_write_b32 v8, v254 offset:16384
    v_mov_b32_dpp v130, v248 quad_perm:[0,0,0,0] row_mask:0xf bank_mask:0xf
    v_mov_b32_dpp v131, v244 quad_perm:[0,0,0,0] row_mask:0xf bank_mask:0xf
    s_nop 0
    v_add_f32_dpp v130, v249, v130 quad_perm:[1,1,1,1] row_mask:0xf bank_mask:0xf
    v_add_f32_dpp v131, v245, v131 quad_perm:[1,1,1,1] row_mask:0xf bank_mask:0xf
    s_nop 0
    v_add_f32_dpp v130, v250, v130 quad_perm:[2,2,2,2] row_mask:0xf bank_mask:0xf
    v_add_f32_dpp v131, v246, v131 quad_perm:[2,2,2,2] row_mask:0xf bank_mask:0xf
    s_nop 0
    v_add_f32_dpp v130, v251, v130 quad_perm:[3,3,3,3] row_mask:0xf bank_mask:0xf
    v_add_f32_dpp v131, v247, v131 quad_perm:[3,3,3,3] row_mask:0xf bank_mask:0xf
    v_cvt_pk_bf16_f32 v3, v130, v131
    v_lshlrev_b32 v130, 16, v3
    v_and_b32 v131, 0xffff0000, v3
    v_mul_f32 v130, s15, v130
    v_mul_f32 v131, s15, v131
    v_cvt_pk_bf16_f32 v3, v130, v131
    v_lshlrev_b32 v130, 16, v3
    v_and_b32 v131, 0xffff0000, v3
    v_max3_f32 v5, v5, v130, v131
    v_mfma_f32_16x16x32_bf16 v[248:251], v[148:151], v[16:19], 0
    v_mfma_f32_16x16x32_bf16 v[248:251], v[152:155], v[20:23], v[248:251]
    v_mfma_f32_16x16x32_bf16 v[244:247], v[156:159], v[16:19], 0
    v_mfma_f32_16x16x32_bf16 v[244:247], v[160:163], v[20:23], v[244:247]
    s_waitcnt vmcnt(6)
    s_cmp_ge_i32 s27, 128
    s_cbranch_scc1 L_hi66
    s_waitcnt vmcnt(5)
    s_cmp_ge_i32 s27, 48
    s_cbranch_scc1 L_hi66
    s_waitcnt vmcnt(4)
    s_cmp_ge_i32 s27, -48
    s_cbranch_scc1 L_hi66
    s_waitcnt vmcnt(3)
L_hi66:
    s_add_u32 s10, s14, 4096
    buffer_load_dwordx4 v[100:103], v2, s[44:47], s10 offen nt
    v_mov_b32 v254, 66
    ds_write_b32 v8, v254 offset:16384
    ds_read_b32 v252, v253 offset:4
    s_waitcnt vmcnt(6)
    s_waitcnt lgkmcnt(0)
    v_readfirstlane_b32 s27, v252
    s_nop 0
    s_cmp_ge_i32 s27, 128
    s_cbranch_scc1 L_hi67
    s_waitcnt vmcnt(5)
    s_cmp_ge_i32 s27, 48
    s_cbranch_scc1 L_hi67
    s_waitcnt vmcnt(4)
    s_cmp_ge_i32 s27, -48
    s_cbranch_scc1 L_hi67
    s_waitcnt vmcnt(3)
L_hi67:
    s_add_u32 s10, s14, 12288
    buffer_load_dwordx4 v[104:107], v2, s[44:47], s10 offen nt
    v_mov_b32 v254, 67
    ds_write_b32 v8, v254 offset:16384
    v_mov_b32_dpp v160, v28 quad_perm:[0,0,0,0] row_mask:0xf bank_mask:0xf
    v_mov_b32_dpp v161, v32 quad_perm:[0,0,0,0] row_mask:0xf bank_mask:0xf
    s_nop 0
    v_add_f32_dpp v160, v29, v160 quad_perm:[1,1,1,1] row_mask:0xf bank_mask:0xf
    v_add_f32_dpp v161, v33, v161 quad_perm:[1,1,1,1] row_mask:0xf bank_mask:0xf
    s_nop 0
    v_add_f32_dpp v160, v30, v160 quad_perm:[2,2,2,2] row_mask:0xf bank_mask:0xf
    v_add_f32_dpp v161, v34, v161 quad_perm:[2,2,2,2] row_mask:0xf bank_mask:0xf
    s_nop 0
    v_add_f32_dpp v160, v31, v160 quad_perm:[3,3,3,3] row_mask:0xf bank_mask:0xf
    v_add_f32_dpp v161, v35, v161 quad_perm:[3,3,3,3] row_mask:0xf bank_mask:0xf
    v_cvt_pk_bf16_f32 v3, v160, v161
    v_lshlrev_b32 v160, 16, v3
    v_and_b32 v161, 0xffff0000, v3
    v_mul_f32 v160, s15, v160
    v_mul_f32 v161, s15, v161
    v_cvt_pk_bf16_f32 v3, v160, v161
    v_lshlrev_b32 v160, 16, v3
    v_and_b32 v161, 0xffff0000, v3
    v_max3_f32 v5, v5, v160, v161
    v_mfma_f32_16x16x32_bf16 v[28:31], v[164:167], v[16:19], 0
    v_mfma_f32_16x16x32_bf16 v[28:31], v[168:171], v[20:23], v[28:31]
    v_mfma_f32_16x16x32_bf16 v[32:35], v[172:175], v[16:19], 0
    v_mfma_f32_16x16x32_bf16 v[32:35], v[176:179], v[20:23], v[32:35]
    s_waitcnt vmcnt(6)
    s_cmp_ge_i32 s27, 128
    s_cbranch_scc1 L_hi68
    s_waitcnt vmcnt(5)
    s_cmp_ge_i32 s27, 48
    s_cbranch_scc1 L_hi68
    s_waitcnt vmcnt(4)
    s_cmp_ge_i32 s27, -48
    s_cbranch_scc1 L_hi68
    s_waitcnt vmcnt(3)
L_hi68:
    s_add_u32 s10, s14, 16384
    buffer_load_dwordx4 v[108:111], v2, s[44:47], s10 offen nt
    v_mov_b32 v254, 68
    ds_write_b32 v8, v254 offset:16384
    ds_read_b32 v252, v253 offset:4
    s_waitcnt vmcnt(6)
    s_waitcnt lgkmcnt(0)
    v_readfirstlane_b32 s27, v252
    s_nop 0
    s_cmp_ge_i32 s27, 128
    s_cbranch_scc1 L_hi69
    s_waitcnt vmcnt(5)
    s_cmp_ge_i32 s27, 48
    s_cbranch_scc1 L_hi69
    s_waitcnt vmcnt(4)
    s_cmp_ge_i32 s27, -48
    s_cbranch_scc1 L_hi69
    s_waitcnt vmcnt(3)
L_hi69:
    s_add_u32 s10, s14, 24576
    buffer_load_dwordx4 v[112:115], v2, s[44:47], s10 offen nt
    v_mov_b32 v254, 69
    ds_write_b32 v8, v254 offset:16384
    v_mov_b32_dpp v162, v248 quad_perm:[0,0,0,0] row_mask:0xf bank_mask:0xf
    v_mov_b32_dpp v163, v244 quad_perm:[0,0,0,0] row_mask:0xf bank_mask:0xf
    s_nop 0
    v_add_f32_dpp v162, v249, v162 quad_perm:[1,1,1,1] row_mask:0xf bank_mask:0xf
    v_add_f32_dpp v163, v245, v163 quad_perm:[1,1,1,1] row_mask:0xf bank_mask:0xf
    s_nop 0
    v_add_f32_dpp v162, v250, v162 quad_perm:[2,2,2,2] row_mask:0xf bank_mask:0xf
    v_add_f32_dpp v163, v246, v163 quad_perm:[2,2,2,2] row_mask:0xf bank_mask:0xf
    s_nop 0
    v_add_f32_dpp v162, v251, v162 quad_perm:[3,3,3,3] row_mask:0xf bank_mask:0xf
    v_add_f32_dpp v163, v247, v163 quad_perm:[3,3,3,3] row_mask:0xf bank_mask:0xf
    v_cvt_pk_bf16_f32 v3, v162, v163
    v_lshlrev_b32 v162, 16, v3
    v_and_b32 v163, 0xffff0000, v3
    v_mul_f32 v162, s15, v162
    v_mul_f32 v163, s15, v163
    v_cvt_pk_bf16_f32 v3, v162, v163
    v_lshlrev_b32 v162, 16, v3
    v_and_b32 v163, 0xffff0000, v3
    v_max3_f32 v5, v5, v162, v163
    v_mfma_f32_16x16x32_bf16 v[248:251], v[180:183], v[16:19], 0
    v_mfma_f32_16x16x32_bf16 v[248:251], v[184:187], v[20:23], v[248:251]
    v_mfma_f32_16x16x32_bf16 v[244:247], v[188:191], v[16:19], 0
    v_mfma_f32_16x16x32_bf16 v[244:247], v[192:195], v[20:23], v[244:247]
    s_waitcnt vmcnt(6)
    s_cmp_ge_i32 s27, 128
    s_cbranch_scc1 L_hi70
    s_waitcnt vmcnt(5)
    s_cmp_ge_i32 s27, 48
    s_cbranch_scc1 L_hi70
    s_waitcnt vmcnt(4)
    s_cmp_ge_i32 s27, -48
    s_cbranch_scc1 L_hi70
    s_waitcnt vmcnt(3)
L_hi70:
    s_add_u32 s10, s14, 20480
    buffer_load_dwordx4 v[116:119], v2, s[44:47], s10 offen nt
    v_mov_b32 v254, 70
    ds_write_b32 v8, v254 offset:16384
    ds_read_b32 v252, v253 offset:4
    s_waitcnt vmcnt(6)
    s_waitcnt lgkmcnt(0)
    v_readfirstlane_b32 s27, v252
    s_nop 0
    s_cmp_ge_i32 s27, 128
    s_cbranch_scc1 L_hi71
    s_waitcnt vmcnt(5)
    s_cmp_ge_i32 s27, 48
    s_cbranch_scc1 L_hi71
    s_waitcnt vmcnt(4)
    s_cmp_ge_i32 s27, -48
    s_cbranch_scc1 L_hi71
    s_waitcnt vmcnt(3)
L_hi71:
    s_add_u32 s10, s14, 28672
    buffer_load_dwordx4 v[120:123], v2, s[44:47], s10 offen nt
    v_mov_b32 v254, 71
    ds_write_b32 v8, v254 offset:16384
    v_mov_b32_dpp v192, v28 quad_perm:[0,0,0,0] row_mask:0xf bank_mask:0xf
    v_mov_b32_dpp v193, v32 quad_perm:[0,0,0,0] row_mask:0xf bank_mask:0xf
    s_nop 0
    v_add_f32_dpp v192, v29, v192 quad_perm:[1,1,1,1] row_mask:0xf bank_mask:0xf
    v_add_f32_dpp v193, v33, v193 quad_perm:[1,1,1,1] row_mask:0xf bank_mask:0xf
    s_nop 0
    v_add_f32_dpp v192, v30, v192 quad_perm:[2,2,2,2] row_mask:0xf bank_mask:0xf
    v_add_f32_dpp v193, v34, v193 quad_perm:[2,2,2,2] row_mask:0xf bank_mask:0xf
    s_nop 0
    v_add_f32_dpp v192, v31, v192 quad_perm:[3,3,3,3] row_mask:0xf bank_mask:0xf
    v_add_f32_dpp v193, v35, v193 quad_perm:[3,3,3,3] row_mask:0xf bank_mask:0xf
    v_cvt_pk_bf16_f32 v3, v192, v193
    v_lshlrev_b32 v192, 16, v3
    v_and_b32 v193, 0xffff0000, v3
    v_mul_f32 v192, s15, v192
    v_mul_f32 v193, s15, v193
    v_cvt_pk_bf16_f32 v3, v192, v193
    v_lshlrev_b32 v192, 16, v3
    v_and_b32 v193, 0xffff0000, v3
    v_max3_f32 v5, v5, v192, v193
    v_mfma_f32_16x16x32_bf16 v[28:31], v[196:199], v[16:19], 0
    v_mfma_f32_16x16x32_bf16 v[28:31], v[200:203], v[20:23], v[28:31]
    v_mfma_f32_16x16x32_bf16 v[32:35], v[204:207], v[16:19], 0
    v_mfma_f32_16x16x32_bf16 v[32:35], v[208:211], v[20:23], v[32:35]
    s_waitcnt vmcnt(6)
    s_cmp_ge_i32 s27, 128
    s_cbranch_scc1 L_hi72
    s_waitcnt vmcnt(5)
    s_cmp_ge_i32 s27, 48
    s_cbranch_scc1 L_hi72
    s_waitcnt vmcnt(4)
    s_cmp_ge_i32 s27, -48
    s_cbranch_scc1 L_hi72
    s_waitcnt vmcnt(3)
L_hi72:
    s_add_u32 s10, s14, 32768
    buffer_load_dwordx4 v[124:127], v2, s[44:47], s10 offen nt
    v_mov_b32 v254, 72
    ds_write_b32 v8, v254 offset:16384
    ds_read_b32 v252, v253 offset:4
    s_waitcnt vmcnt(6)
    s_waitcnt lgkmcnt(0)
    v_readfirstlane_b32 s27, v252
    s_nop 0
    s_cmp_ge_i32 s27, 128
    s_cbranch_scc1 L_hi73
    s_waitcnt vmcnt(5)
    s_cmp_ge_i32 s27, 48
    s_cbranch_scc1 L_hi73
    s_waitcnt vmcnt(4)
    s_cmp_ge_i32 s27, -48
    s_cbranch_scc1 L_hi73
    s_waitcnt vmcnt(3)
L_hi73:
    s_add_u32 s10, s14, 40960
    buffer_load_dwordx4 v[132:135], v2, s[44:47], s10 offen nt
    v_mov_b32 v254, 73
    ds_write_b32 v8, v254 offset:16384
    v_mov_b32_dpp v194, v248 quad_perm:[0,0,0,0] row_mask:0xf bank_mask:0xf
    v_mov_b32_dpp v195, v244 quad_perm:[0,0,0,0] row_mask:0xf bank_mask:0xf
    s_nop 0
    v_add_f32_dpp v194, v249, v194 quad_perm:[1,1,1,1] row_mask:0xf bank_mask:0xf
    v_add_f32_dpp v195, v245, v195 quad_perm:[1,1,1,1] row_mask:0xf bank_mask:0xf
    s_nop 0
    v_add_f32_dpp v194, v250, v194 quad_perm:[2,2,2,2] row_mask:0xf bank_mask:0xf
    v_add_f32_dpp v195, v246, v195 quad_perm:[2,2,2,2] row_mask:0xf bank_mask:0xf
    s_nop 0
    v_add_f32_dpp v194, v251, v194 quad_perm:[3,3,3,3] row_mask:0xf bank_mask:0xf
    v_add_f32_dpp v195, v247, v195 quad_perm:[3,3,3,3] row_mask:0xf bank_mask:0xf
    v_cvt_pk_bf16_f32 v3, v194, v195
    v_lshlrev_b32 v194, 16, v3
    v_and_b32 v195, 0xffff0000, v3
    v_mul_f32 v194, s15, v194
    v_mul_f32 v195, s15, v195
    v_cvt_pk_bf16_f32 v3, v194, v195
    v_lshlrev_b32 v194, 16, v3
    v_and_b32 v195, 0xffff0000, v3
    v_max3_f32 v5, v5, v194, v195
    v_mfma_f32_16x16x32_bf16 v[248:251], v[212:215], v[16:19], 0
    v_mfma_f32_16x16x32_bf16 v[248:251], v[216:219], v[20:23], v[248:251]
    v_mfma_f32_16x16x32_bf16 v[244:247], v[220:223], v[16:19], 0
    v_mfma_f32_16x16x32_bf16 v[244:247], v[224:227], v[20:23], v[244:247]
    s_waitcnt vmcnt(6)
    s_cmp_ge_i32 s27, 128
    s_cbranch_scc1 L_hi74
    s_waitcnt vmcnt(5)
    s_cmp_ge_i32 s27, 48
    s_cbranch_scc1 L_hi74
    s_waitcnt vmcnt(4)
    s_cmp_ge_i32 s27, -48
    s_cbranch_scc1 L_hi74
    s_waitcnt vmcnt(3)
L_hi74:
    s_add_u32 s10, s14, 36864
    buffer_load_dwordx4 v[136:139], v2, s[44:47], s10 offen nt
    v_mov_b32 v254, 74
    ds_write_b32 v8, v254 offset:16384
    ds_read_b32 v252, v253 offset:4
    s_waitcnt vmcnt(6)
    s_waitcnt lgkmcnt(0)
    v_readfirstlane_b32 s27, v252
    s_nop 0
    s_cmp_ge_i32 s27, 128
    s_cbranch_scc1 L_hi75
    s_waitcnt vmcnt(5)
    s_cmp_ge_i32 s27, 48
    s_cbranch_scc1 L_hi75
    s_waitcnt vmcnt(4)
    s_cmp_ge_i32 s27, -48
    s_cbranch_scc1 L_hi75
    s_waitcnt vmcnt(3)
L_hi75:
    s_add_u32 s10, s14, 45056
    buffer_load_dwordx4 v[140:143], v2, s[44:47], s10 offen nt
    v_mov_b32 v254, 75
    ds_write_b32 v8, v254 offset:16384
    v_mov_b32_dpp v224, v28 quad_perm:[0,0,0,0] row_mask:0xf bank_mask:0xf
    v_mov_b32_dpp v225, v32 quad_perm:[0,0,0,0] row_mask:0xf bank_mask:0xf
    s_nop 0
    v_add_f32_dpp v224, v29, v224 quad_perm:[1,1,1,1] row_mask:0xf bank_mask:0xf
    v_add_f32_dpp v225, v33, v225 quad_perm:[1,1,1,1] row_mask:0xf bank_mask:0xf
    s_nop 0
    v_add_f32_dpp v224, v30, v224 quad_perm:[2,2,2,2] row_mask:0xf bank_mask:0xf
    v_add_f32_dpp v225, v34, v225 quad_perm:[2,2,2,2] row_mask:0xf bank_mask:0xf
    s_nop 0
    v_add_f32_dpp v224, v31, v224 quad_perm:[3,3,3,3] row_mask:0xf bank_mask:0xf
    v_add_f32_dpp v225, v35, v225 quad_perm:[3,3,3,3] row_mask:0xf bank_mask:0xf
    v_cvt_pk_bf16_f32 v3, v224, v225
    v_lshlrev_b32 v224, 16, v3
    v_and_b32 v225, 0xffff0000, v3
    v_mul_f32 v224, s15, v224
    v_mul_f32 v225, s15, v225
    v_cvt_pk_bf16_f32 v3, v224, v225
    v_lshlrev_b32 v224, 16, v3
    v_and_b32 v225, 0xffff0000, v3
    v_max3_f32 v5, v5, v224, v225
    v_mfma_f32_16x16x32_bf16 v[28:31], v[228:231], v[16:19], 0
    v_mfma_f32_16x16x32_bf16 v[28:31], v[232:235], v[20:23], v[28:31]
    v_mfma_f32_16x16x32_bf16 v[32:35], v[236:239], v[16:19], 0
    v_mfma_f32_16x16x32_bf16 v[32:35], v[240:243], v[20:23], v[32:35]
    s_waitcnt vmcnt(6)
    s_cmp_ge_i32 s27, 128
    s_cbranch_scc1 L_hi76
    s_waitcnt vmcnt(5)
    s_cmp_ge_i32 s27, 48
    s_cbranch_scc1 L_hi76
    s_waitcnt vmcnt(4)
    s_cmp_ge_i32 s27, -48
    s_cbranch_scc1 L_hi76
    s_waitcnt vmcnt(3)
L_hi76:
    s_add_u32 s10, s14, 49152
    buffer_load_dwordx4 v[144:147], v2, s[44:47], s10 offen nt
    v_mov_b32 v254, 76
    ds_write_b32 v8, v254 offset:16384
    ds_read_b32 v252, v253 offset:4
    s_waitcnt vmcnt(6)
    s_waitcnt lgkmcnt(0)
    v_readfirstlane_b32 s27, v252
    s_nop 0
    s_cmp_ge_i32 s27, 128
    s_cbranch_scc1 L_hi77
    s_waitcnt vmcnt(5)
    s_cmp_ge_i32 s27, 48
    s_cbranch_scc1 L_hi77
    s_waitcnt vmcnt(4)
    s_cmp_ge_i32 s27, -48
    s_cbranch_scc1 L_hi77
    s_waitcnt vmcnt(3)
L_hi77:
    s_add_u32 s10, s14, 57344
    buffer_load_dwordx4 v[148:151], v2, s[44:47], s10 offen nt
    v_mov_b32 v254, 77
    ds_write_b32 v8, v254 offset:16384
    v_mov_b32_dpp v226, v248 quad_perm:[0,0,0,0] row_mask:0xf bank_mask:0xf
    v_mov_b32_dpp v227, v244 quad_perm:[0,0,0,0] row_mask:0xf bank_mask:0xf
    s_nop 0
    v_add_f32_dpp v226, v249, v226 quad_perm:[1,1,1,1] row_mask:0xf bank_mask:0xf
    v_add_f32_dpp v227, v245, v227 quad_perm:[1,1,1,1] row_mask:0xf bank_mask:0xf
    s_nop 0
    v_add_f32_dpp v226, v250, v226 quad_perm:[2,2,2,2] row_mask:0xf bank_mask:0xf
    v_add_f32_dpp v227, v246, v227 quad_perm:[2,2,2,2] row_mask:0xf bank_mask:0xf
    s_nop 0
    v_add_f32_dpp v226, v251, v226 quad_perm:[3,3,3,3] row_mask:0xf bank_mask:0xf
    v_add_f32_dpp v227, v247, v227 quad_perm:[3,3,3,3] row_mask:0xf bank_mask:0xf
    v_cvt_pk_bf16_f32 v3, v226, v227
    v_lshlrev_b32 v226, 16, v3
    v_and_b32 v227, 0xffff0000, v3
    v_mul_f32 v226, s15, v226
    v_mul_f32 v227, s15, v227
    v_cvt_pk_bf16_f32 v3, v226, v227
    v_lshlrev_b32 v226, 16, v3
    v_and_b32 v227, 0xffff0000, v3
    v_max3_f32 v5, v5, v226, v227
    v_mfma_f32_16x16x32_bf16 v[248:251], v[36:39], v[16:19], 0
    v_mfma_f32_16x16x32_bf16 v[248:251], v[40:43], v[20:23], v[248:251]
    v_mfma_f32_16x16x32_bf16 v[244:247], v[44:47], v[16:19], 0
    v_mfma_f32_16x16x32_bf16 v[244:247], v[48:51], v[20:23], v[244:247]
    s_waitcnt vmcnt(6)
    s_cmp_ge_i32 s27, 128
    s_cbranch_scc1 L_hi78
    s_waitcnt vmcnt(5)
    s_cmp_ge_i32 s27, 48
    s_cbranch_scc1 L_hi78
    s_waitcnt vmcnt(4)
    s_cmp_ge_i32 s27, -48
    s_cbranch_scc1 L_hi78
    s_waitcnt vmcnt(3)
L_hi78:
    s_add_u32 s10, s14, 53248
    buffer_load_dwordx4 v[152:155], v2, s[44:47], s10 offen nt
    v_mov_b32 v254, 78
    ds_write_b32 v8, v254 offset:16384
    ds_read_b32 v252, v253 offset:4
    s_waitcnt vmcnt(6)
    s_waitcnt lgkmcnt(0)
    v_readfirstlane_b32 s27, v252
    s_nop 0
    s_cmp_ge_i32 s27, 128
    s_cbranch_scc1 L_hi79
    s_waitcnt vmcnt(5)
    s_cmp_ge_i32 s27, 48
    s_cbranch_scc1 L_hi79
    s_waitcnt vmcnt(4)
    s_cmp_ge_i32 s27, -48
    s_cbranch_scc1 L_hi79
    s_waitcnt vmcnt(3)
L_hi79:
    s_add_u32 s10, s14, 61440
    buffer_load_dwordx4 v[156:159], v2, s[44:47], s10 offen nt
    v_mov_b32 v254, 79
    ds_write_b32 v8, v254 offset:16384
    v_mov_b32_dpp v48, v28 quad_perm:[0,0,0,0] row_mask:0xf bank_mask:0xf
    v_mov_b32_dpp v49, v32 quad_perm:[0,0,0,0] row_mask:0xf bank_mask:0xf
    s_nop 0
    v_add_f32_dpp v48, v29, v48 quad_perm:[1,1,1,1] row_mask:0xf bank_mask:0xf
    v_add_f32_dpp v49, v33, v49 quad_perm:[1,1,1,1] row_mask:0xf bank_mask:0xf
    s_nop 0
    v_add_f32_dpp v48, v30, v48 quad_perm:[2,2,2,2] row_mask:0xf bank_mask:0xf
    v_add_f32_dpp v49, v34, v49 quad_perm:[2,2,2,2] row_mask:0xf bank_mask:0xf
    s_nop 0
    v_add_f32_dpp v48, v31, v48 quad_perm:[3,3,3,3] row_mask:0xf bank_mask:0xf
    v_add_f32_dpp v49, v35, v49 quad_perm:[3,3,3,3] row_mask:0xf bank_mask:0xf
    v_cvt_pk_bf16_f32 v3, v48, v49
    v_lshlrev_b32 v48, 16, v3
    v_and_b32 v49, 0xffff0000, v3
    v_mul_f32 v48, s15, v48
    v_mul_f32 v49, s15, v49
    v_cvt_pk_bf16_f32 v3, v48, v49
    v_lshlrev_b32 v48, 16, v3
    v_and_b32 v49, 0xffff0000, v3
    v_max3_f32 v5, v5, v48, v49
    v_mfma_f32_16x16x32_bf16 v[28:31], v[52:55], v[16:19], 0
    v_mfma_f32_16x16x32_bf16 v[28:31], v[56:59], v[20:23], v[28:31]
    v_mfma_f32_16x16x32_bf16 v[32:35], v[60:63], v[16:19], 0
    v_mfma_f32_16x16x32_bf16 v[32:35], v[68:71], v[20:23], v[32:35]
    s_waitcnt vmcnt(6)
    s_cmp_ge_i32 s27, 128
    s_cbranch_scc1 L_hi80
    s_waitcnt vmcnt(5)
    s_cmp_ge_i32 s27, 48
    s_cbranch_scc1 L_hi80
    s_waitcnt vmcnt(4)
    s_cmp_ge_i32 s27, -48
    s_cbranch_scc1 L_hi80
    s_waitcnt vmcnt(3)
L_hi80:
    s_add_u32 s10, s14, 131072
    buffer_load_dwordx4 v[164:167], v2, s[44:47], s10 offen nt
    v_mov_b32 v254, 80
    ds_write_b32 v8, v254 offset:16384
    ds_read_b32 v252, v253 offset:4
    s_waitcnt vmcnt(6)
    s_waitcnt lgkmcnt(0)
    v_readfirstlane_b32 s27, v252
    s_nop 0
    s_cmp_ge_i32 s27, 128
    s_cbranch_scc1 L_hi81
    s_waitcnt vmcnt(5)
    s_cmp_ge_i32 s27, 48
    s_cbranch_scc1 L_hi81
    s_waitcnt vmcnt(4)
    s_cmp_ge_i32 s27, -48
    s_cbranch_scc1 L_hi81
    s_waitcnt vmcnt(3)
L_hi81:
    s_add_u32 s10, s14, 139264
    buffer_load_dwordx4 v[168:171], v2, s[44:47], s10 offen nt
    v_mov_b32 v254, 81
    ds_write_b32 v8, v254 offset:16384
    v_mov_b32_dpp v50, v248 quad_perm:[0,0,0,0] row_mask:0xf bank_mask:0xf
    v_mov_b32_dpp v51, v244 quad_perm:[0,0,0,0] row_mask:0xf bank_mask:0xf
    s_nop 0
    v_add_f32_dpp v50, v249, v50 quad_perm:[1,1,1,1] row_mask:0xf bank_mask:0xf
    v_add_f32_dpp v51, v245, v51 quad_perm:[1,1,1,1] row_mask:0xf bank_mask:0xf
    s_nop 0
    v_add_f32_dpp v50, v250, v50 quad_perm:[2,2,2,2] row_mask:0xf bank_mask:0xf
    v_add_f32_dpp v51, v246, v51 quad_perm:[2,2,2,2] row_mask:0xf bank_mask:0xf
    s_nop 0
    v_add_f32_dpp v50, v251, v50 quad_perm:[3,3,3,3] row_mask:0xf bank_mask:0xf
    v_add_f32_dpp v51, v247, v51 quad_perm:[3,3,3,3] row_mask:0xf bank_mask:0xf
    v_cvt_pk_bf16_f32 v3, v50, v51
    v_lshlrev_b32 v50, 16, v3
    v_and_b32 v51, 0xffff0000, v3
    v_mul_f32 v50, s15, v50
    v_mul_f32 v51, s15, v51
    v_cvt_pk_bf16_f32 v3, v50, v51
    v_lshlrev_b32 v50, 16, v3
    v_and_b32 v51, 0xffff0000, v3
    v_max3_f32 v5, v5, v50, v51
    v_mfma_f32_16x16x32_bf16 v[248:251], v[72:75], v[16:19], 0
    v_mfma_f32_16x16x32_bf16 v[248:251], v[76:79], v[20:23], v[248:251]
    v_mfma_f32_16x16x32_bf16 v[244:247], v[80:83], v[16:19], 0
    v_mfma_f32_16x16x32_bf16 v[244:247], v[84:87], v[20:23], v[244:247]
    s_waitcnt vmcnt(6)
    s_cmp_ge_i32 s27, 128
    s_cbranch_scc1 L_hi82
    s_waitcnt vmcnt(5)
    s_cmp_ge_i32 s27, 48
    s_cbranch_scc1 L_hi82
    s_waitcnt vmcnt(4)
    s_cmp_ge_i32 s27, -48
    s_cbranch_scc1 L_hi82
    s_waitcnt vmcnt(3)
L_hi82:
    s_add_u32 s10, s14, 135168
    buffer_load_dwordx4 v[172:175], v2, s[44:47], s10 offen nt
    v_mov_b32 v254, 82
    ds_write_b32 v8, v254 offset:16384
    ds_read_b32 v252, v253 offset:4
    s_waitcnt vmcnt(6)
    s_waitcnt lgkmcnt(0)
    v_readfirstlane_b32 s27, v252
    s_nop 0
    s_cmp_ge_i32 s27, 128
    s_cbranch_scc1 L_hi83
    s_waitcnt vmcnt(5)
    s_cmp_ge_i32 s27, 48
    s_cbranch_scc1 L_hi83
    s_waitcnt vmcnt(4)
    s_cmp_ge_i32 s27, -48
    s_cbranch_scc1 L_hi83
    s_waitcnt vmcnt(3)
L_hi83:
    s_add_u32 s10, s14, 143360
    buffer_load_dwordx4 v[176:179], v2, s[44:47], s10 offen nt
    v_mov_b32 v254, 83
    ds_write_b32 v8, v254 offset:16384
    v_mov_b32_dpp v84, v28 quad_perm:[0,0,0,0] row_mask:0xf bank_mask:0xf
    v_mov_b32_dpp v85, v32 quad_perm:[0,0,0,0] row_mask:0xf bank_mask:0xf
    s_nop 0
    v_add_f32_dpp v84, v29, v84 quad_perm:[1,1,1,1] row_mask:0xf bank_mask:0xf
    v_add_f32_dpp v85, v33, v85 quad_perm:[1,1,1,1] row_mask:0xf bank_mask:0xf
    s_nop 0
    v_add_f32_dpp v84, v30, v84 quad_perm:[2,2,2,2] row_mask:0xf bank_mask:0xf
    v_add_f32_dpp v85, v34, v85 quad_perm:[2,2,2,2] row_mask:0xf bank_mask:0xf
    s_nop 0
    v_add_f32_dpp v84, v31, v84 quad_perm:[3,3,3,3] row_mask:0xf bank_mask:0xf
    v_add_f32_dpp v85, v35, v85 quad_perm:[3,3,3,3] row_mask:0xf bank_mask:0xf
    v_cvt_pk_bf16_f32 v3, v84, v85
    v_lshlrev_b32 v84, 16, v3
    v_and_b32 v85, 0xffff0000, v3
    v_mul_f32 v84, s15, v84
    v_mul_f32 v85, s15, v85
    v_cvt_pk_bf16_f32 v3, v84, v85
    v_lshlrev_b32 v84, 16, v3
    v_and_b32 v85, 0xffff0000, v3
    v_max3_f32 v5, v5, v84, v85
    v_mov_b32_dpp v86, v248 quad_perm:[0,0,0,0] row_mask:0xf bank_mask:0xf
    v_mov_b32_dpp v87, v244 quad_perm:[0,0,0,0] row_mask:0xf bank_mask:0xf
    s_nop 0
    v_add_f32_dpp v86, v249, v86 quad_perm:[1,1,1,1] row_mask:0xf bank_mask:0xf
    v_add_f32_dpp v87, v245, v87 quad_perm:[1,1,1,1] row_mask:0xf bank_mask:0xf
    s_nop 0
    v_add_f32_dpp v86, v250, v86 quad_perm:[2,2,2,2] row_mask:0xf bank_mask:0xf
    v_add_f32_dpp v87, v246, v87 quad_perm:[2,2,2,2] row_mask:0xf bank_mask:0xf
    s_nop 0
    v_add_f32_dpp v86, v251, v86 quad_perm:[3,3,3,3] row_mask:0xf bank_mask:0xf
    v_add_f32_dpp v87, v247, v87 quad_perm:[3,3,3,3] row_mask:0xf bank_mask:0xf
    v_cvt_pk_bf16_f32 v3, v86, v87
    v_lshlrev_b32 v86, 16, v3
    v_and_b32 v87, 0xffff0000, v3
    v_mul_f32 v86, s15, v86
    v_mul_f32 v87, s15, v87
    v_cvt_pk_bf16_f32 v3, v86, v87
    v_lshlrev_b32 v86, 16, v3
    v_and_b32 v87, 0xffff0000, v3
    v_max3_f32 v5, v5, v86, v87
    s_waitcnt vmcnt(6)
    s_cmp_ge_i32 s27, 128
    s_cbranch_scc1 L_hi84
    s_waitcnt vmcnt(5)
    s_cmp_ge_i32 s27, 48
    s_cbranch_scc1 L_hi84
    s_waitcnt vmcnt(4)
    s_cmp_ge_i32 s27, -48
    s_cbranch_scc1 L_hi84
    s_waitcnt vmcnt(3)
L_hi84:
    s_add_u32 s10, s14, 147456
    buffer_load_dwordx4 v[180:183], v2, s[44:47], s10 offen nt
    v_mov_b32 v254, 84
    ds_write_b32 v8, v254 offset:16384
    ds_read_b32 v252, v253 offset:4
    v_max_f32_dpp v5, v5, v5 row_ror:8 row_mask:0xf bank_mask:0xf
    v_mov_b32 v3, v5
    s_nop 1
    v_permlane16_swap_b32 v5, v3
    v_max_f32 v5, v5, v3
    v_mov_b32 v3, v5
    s_nop 1
    v_permlane32_swap_b32 v5, v3
    v_max_f32 v5, v5, v3
    s_mov_b32 s15, 0x3fb8aa3b
    v_mul_f32 v5, s15, v5
    v_mov_b32 v6, 0
    v_mov_b32 v4, 0
    v_fma_f32 v64, v64, s15, -v5
    v_fma_f32 v65, v65, s15, -v5
    v_fma_f32 v66, v66, s15, -v5
    v_fma_f32 v67, v67, s15, -v5
    v_exp_f32 v64, v64
    v_exp_f32 v65, v65
    v_exp_f32 v66, v66
    v_exp_f32 v67, v67
    v_add_f32 v6, v6, v64
    v_add_f32 v4, v4, v65
    v_add_f32 v6, v6, v66
    v_add_f32 v4, v4, v67
    v_cvt_pk_bf16_f32 v64, v64, v64
    v_cvt_pk_bf16_f32 v65, v65, v65
    v_cvt_pk_bf16_f32 v66, v66, v66
    v_cvt_pk_bf16_f32 v67, v67, v67
    v_fma_f32 v96, v96, s15, -v5
    v_fma_f32 v97, v97, s15, -v5
    v_fma_f32 v98, v98, s15, -v5
    v_fma_f32 v99, v99, s15, -v5
    v_exp_f32 v96, v96
    v_exp_f32 v97, v97
    v_exp_f32 v98, v98
    v_exp_f32 v99, v99
    v_add_f32 v6, v6, v96
    v_add_f32 v4, v4, v97
    v_add_f32 v6, v6, v98
    v_add_f32 v4, v4, v99
    v_cvt_pk_bf16_f32 v96, v96, v96
    v_cvt_pk_bf16_f32 v97, v97, v97
    v_cvt_pk_bf16_f32 v98, v98, v98
    v_cvt_pk_bf16_f32 v99, v99, v99
    s_waitcnt vmcnt(6)
    s_waitcnt lgkmcnt(0)
    v_readfirstlane_b32 s27, v252
    s_nop 0
    s_cmp_ge_i32 s27, 128
    s_cbranch_scc1 L_hi85
    s_waitcnt vmcnt(5)
    s_cmp_ge_i32 s27, 48
    s_cbranch_scc1 L_hi85
    s_waitcnt vmcnt(4)
    s_cmp_ge_i32 s27, -48
    s_cbranch_scc1 L_hi85
    s_waitcnt vmcnt(3)
L_hi85:
    s_add_u32 s10, s14, 155648
    buffer_load_dwordx4 v[184:187], v2, s[44:47], s10 offen nt
    v_mov_b32 v254, 85
    ds_write_b32 v8, v254 offset:16384
    v_fma_f32 v128, v128, s15, -v5
    v_fma_f32 v129, v129, s15, -v5
    v_fma_f32 v130, v130, s15, -v5
    v_fma_f32 v131, v131, s15, -v5
    v_exp_f32 v128, v128
    v_exp_f32 v129, v129
    v_exp_f32 v130, v130
    v_exp_f32 v131, v131
    v_add_f32 v6, v6, v128
    v_add_f32 v4, v4, v129
    v_add_f32 v6, v6, v130
    v_add_f32 v4, v4, v131
    v_cvt_pk_bf16_f32 v128, v128, v128
    v_cvt_pk_bf16_f32 v129, v129, v129
    v_cvt_pk_bf16_f32 v130, v130, v130
    v_cvt_pk_bf16_f32 v131, v131, v131
    v_fma_f32 v160, v160, s15, -v5
    v_fma_f32 v161, v161, s15, -v5
    v_fma_f32 v162, v162, s15, -v5
    v_fma_f32 v163, v163, s15, -v5
    v_exp_f32 v160, v160
    v_exp_f32 v161, v161
    v_exp_f32 v162, v162
    v_exp_f32 v163, v163
    v_add_f32 v6, v6, v160
    v_add_f32 v4, v4, v161
    v_add_f32 v6, v6, v162
    v_add_f32 v4, v4, v163
    v_cvt_pk_bf16_f32 v160, v160, v160
    v_cvt_pk_bf16_f32 v161, v161, v161
    v_cvt_pk_bf16_f32 v162, v162, v162
    v_cvt_pk_bf16_f32 v163, v163, v163
    s_waitcnt vmcnt(6)
    s_cmp_ge_i32 s27, 128
    s_cbranch_scc1 L_hi86
    s_waitcnt vmcnt(5)
    s_cmp_ge_i32 s27, 48
    s_cbranch_scc1 L_hi86
    s_waitcnt vmcnt(4)
    s_cmp_ge_i32 s27, -48
    s_cbranch_scc1 L_hi86
    s_waitcnt vmcnt(3)
L_hi86:
    s_add_u32 s10, s14, 151552
    buffer_load_dwordx4 v[188:191], v2, s[44:47], s10 offen nt
    v_mov_b32 v254, 86
    ds_write_b32 v8, v254 offset:16384
    ds_read_b32 v252, v253 offset:4
    v_fma_f32 v192, v192, s15, -v5
    v_fma_f32 v193, v193, s15, -v5
    v_fma_f32 v194, v194, s15, -v5
    v_fma_f32 v195, v195, s15, -v5
    v_exp_f32 v192, v192
    v_exp_f32 v193, v193
    v_exp_f32 v194, v194
    v_exp_f32 v195, v195
    v_add_f32 v6, v6, v192
    v_add_f32 v4, v4, v193
    v_add_f32 v6, v6, v194
    v_add_f32 v4, v4, v195
    v_cvt_pk_bf16_f32 v192, v192, v192
    v_cvt_pk_bf16_f32 v193, v193, v193
    v_cvt_pk_bf16_f32 v194, v194, v194
    v_cvt_pk_bf16_f32 v195, v195, v195
    v_fma_f32 v224, v224, s15, -v5
    v_fma_f32 v225, v225, s15, -v5
    v_fma_f32 v226, v226, s15, -v5
    v_fma_f32 v227, v227, s15, -v5
    v_exp_f32 v224, v224
    v_exp_f32 v225, v225
    v_exp_f32 v226, v226
    v_exp_f32 v227, v227
    v_add_f32 v6, v6, v224
    v_add_f32 v4, v4, v225
    v_add_f32 v6, v6, v226
    v_add_f32 v4, v4, v227
    v_cvt_pk_bf16_f32 v224, v224, v224
    v_cvt_pk_bf16_f32 v225, v225, v225
    v_cvt_pk_bf16_f32 v226, v226, v226
    v_cvt_pk_bf16_f32 v227, v227, v227
    s_waitcnt vmcnt(6)
    s_waitcnt lgkmcnt(0)
    v_readfirstlane_b32 s27, v252
    s_nop 0
    s_cmp_ge_i32 s27, 128
    s_cbranch_scc1 L_hi87
    s_waitcnt vmcnt(5)
    s_cmp_ge_i32 s27, 48
    s_cbranch_scc1 L_hi87
    s_waitcnt vmcnt(4)
    s_cmp_ge_i32 s27, -48
    s_cbranch_scc1 L_hi87
    s_waitcnt vmcnt(3)
L_hi87:
    s_add_u32 s10, s14, 159744
    buffer_load_dwordx4 v[196:199], v2, s[44:47], s10 offen nt
    v_mov_b32 v254, 87
    ds_write_b32 v8, v254 offset:16384
    v_fma_f32 v48, v48, s15, -v5
    v_fma_f32 v49, v49, s15, -v5
    v_fma_f32 v50, v50, s15, -v5
    v_fma_f32 v51, v51, s15, -v5
    v_exp_f32 v48, v48
    v_exp_f32 v49, v49
    v_exp_f32 v50, v50
    v_exp_f32 v51, v51
    v_add_f32 v6, v6, v48
    v_add_f32 v4, v4, v49
    v_add_f32 v6, v6, v50
    v_add_f32 v4, v4, v51
    v_cvt_pk_bf16_f32 v48, v48, v48
    v_cvt_pk_bf16_f32 v49, v49, v49
    v_cvt_pk_bf16_f32 v50, v50, v50
    v_cvt_pk_bf16_f32 v51, v51, v51
    v_fma_f32 v84, v84, s15, -v5
    v_fma_f32 v85, v85, s15, -v5
    v_fma_f32 v86, v86, s15, -v5
    v_fma_f32 v87, v87, s15, -v5
    v_exp_f32 v84, v84
    v_exp_f32 v85, v85
    v_exp_f32 v86, v86
    v_exp_f32 v87, v87
    v_add_f32 v6, v6, v84
    v_add_f32 v4, v4, v85
    v_add_f32 v6, v6, v86
    v_add_f32 v4, v4, v87
    v_cvt_pk_bf16_f32 v84, v84, v84
    v_cvt_pk_bf16_f32 v85, v85, v85
    v_cvt_pk_bf16_f32 v86, v86, v86
    v_cvt_pk_bf16_f32 v87, v87, v87
    s_waitcnt vmcnt(6)
    s_cmp_ge_i32 s27, 128
    s_cbranch_scc1 L_hi88
    s_waitcnt vmcnt(5)
    s_cmp_ge_i32 s27, 48
    s_cbranch_scc1 L_hi88
    s_waitcnt vmcnt(4)
    s_cmp_ge_i32 s27, -48
    s_cbranch_scc1 L_hi88
    s_waitcnt vmcnt(3)
L_hi88:
    s_add_u32 s10, s14, 163840
    buffer_load_dwordx4 v[200:203], v2, s[44:47], s10 offen nt
    v_mov_b32 v254, 88
    ds_write_b32 v8, v254 offset:16384
    ds_read_b32 v252, v253 offset:4
    v_add_f32 v6, v6, v4
    s_nop 1
    v_add_f32_dpp v6, v6, v6 row_ror:8 row_mask:0xf bank_mask:0xf
    v_mov_b32 v3, v6
    s_nop 1
    v_permlane16_swap_b32 v6, v3
    v_add_f32 v6, v6, v3
    v_mov_b32 v3, v6
    s_nop 1
    v_permlane32_swap_b32 v6, v3
    v_add_f32 v6, v6, v3
    v_min_u32 v10, -2, v5
    v_min_u32 v11, -2, v6
    v_lshlrev_b32 v9, 1, v0
    v_and_b32 v9, 0x38, v9
    v_lshrrev_b32 v3, 5, v0
    v_lshl_or_b32 v9, v3, 7, v9
    s_lshl_b32 s73, s6, 8
    s_add_u32 s73, s73, 262144
    s_lshl_b32 s4, s7, 3
    s_add_u32 s4, s4, s3
    s_lshl_b32 s4, s4, 4
    s_add_u32 s4, s4, s73
    s_mov_b64 exec, 0x11
    s_cmp_eq_u32 s100, 0
    s_cbranch_scc1 L_far1
    buffer_store_dwordx2 v[10:11], v9, s[52:55], s4 offen
    s_branch L_sent2
L_far1:
    buffer_store_dwordx2 v[10:11], v9, s[52:55], s4 offen sc1
L_sent2:
    s_mov_b64 exec, -1
    v_and_b32 v28, v64, v12
    v_and_b32 v29, v64, v13
    v_and_b32_dpp v30, v64, v14 row_ror:8 row_mask:0xf bank_mask:0xf
    v_and_b32_dpp v31, v64, v15 row_ror:8 row_mask:0xf bank_mask:0xf
    s_nop 1
    v_mfma_f32_16x16x32_bf16 v[24:27], v[88:91], v[28:31], 0
    v_and_b32_dpp v32, v64, v12 row_ror:8 row_mask:0xf bank_mask:0xf
    v_and_b32_dpp v33, v64, v13 row_ror:8 row_mask:0xf bank_mask:0xf
    v_and_b32 v34, v64, v14
    v_and_b32 v35, v64, v15
    s_nop 1
    v_mfma_f32_16x16x32_bf16 v[24:27], v[92:95], v[32:35], v[24:27]
    s_waitcnt vmcnt(7)
    s_waitcnt lgkmcnt(0)
    v_readfirstlane_b32 s27, v252
    s_nop 0
    s_cmp_ge_i32 s27, 128
    s_cbranch_scc1 L_hi89
    s_waitcnt vmcnt(6)
    s_cmp_ge_i32 s27, 48
    s_cbranch_scc1 L_hi89
    s_waitcnt vmcnt(5)
    s_cmp_ge_i32 s27, -48
    s_cbranch_scc1 L_hi89
    s_waitcnt vmcnt(4)
L_hi89:
    s_add_u32 s10, s14, 172032
    buffer_load_dwordx4 v[204:207], v2, s[44:47], s10 offen nt
    v_mov_b32 v254, 89
    ds_write_b32 v8, v254 offset:16384
    v_and_b32 v28, v65, v12
    v_and_b32 v29, v65, v13
    v_and_b32_dpp v30, v65, v14 row_ror:8 row_mask:0xf bank_mask:0xf
    v_and_b32_dpp v31, v65, v15 row_ror:8 row_mask:0xf bank_mask:0xf
    s_nop 1
    v_mfma_f32_16x16x32_bf16 v[24:27], v[100:103], v[28:31], v[24:27]
    v_and_b32_dpp v32, v65, v12 row_ror:8 row_mask:0xf bank_mask:0xf
    v_and_b32_dpp v33, v65, v13 row_ror:8 row_mask:0xf bank_mask:0xf
    v_and_b32 v34, v65, v14
    v_and_b32 v35, v65, v15
    s_nop 1
    v_mfma_f32_16x16x32_bf16 v[24:27], v[104:107], v[32:35], v[24:27]
    s_waitcnt vmcnt(7)
    s_cmp_ge_i32 s27, 128
    s_cbranch_scc1 L_hi90
    s_waitcnt vmcnt(6)
    s_cmp_ge_i32 s27, 48
    s_cbranch_scc1 L_hi90
    s_waitcnt vmcnt(5)
    s_cmp_ge_i32 s27, -48
    s_cbranch_scc1 L_hi90
    s_waitcnt vmcnt(4)
L_hi90:
    s_add_u32 s10, s14, 167936
    buffer_load_dwordx4 v[208:211], v2, s[44:47], s10 offen nt
    v_mov_b32 v254, 90
    ds_write_b32 v8, v254 offset:16384
    ds_read_b32 v252, v253 offset:4
    v_and_b32 v28, v66, v12
    v_and_b32 v29, v66, v13
    v_and_b32_dpp v30, v66, v14 row_ror:8 row_mask:0xf bank_mask:0xf
    v_and_b32_dpp v31, v66, v15 row_ror:8 row_mask:0xf bank_mask:0xf
    s_nop 1
    v_mfma_f32_16x16x32_bf16 v[24:27], v[108:111], v[28:31], v[24:27]
    v_and_b32_dpp v32, v66, v12 row_ror:8 row_mask:0xf bank_mask:0xf
    v_and_b32_dpp v33, v66, v13 row_ror:8 row_mask:0xf bank_mask:0xf
    v_and_b32 v34, v66, v14
    v_and_b32 v35, v66, v15
    s_nop 1
    v_mfma_f32_16x16x32_bf16 v[24:27], v[112:115], v[32:35], v[24:27]
    s_waitcnt vmcnt(7)
    s_waitcnt lgkmcnt(0)
    v_readfirstlane_b32 s27, v252
    s_nop 0
    s_cmp_ge_i32 s27, 128
    s_cbranch_scc1 L_hi91
    s_waitcnt vmcnt(6)
    s_cmp_ge_i32 s27, 48
    s_cbranch_scc1 L_hi91
    s_waitcnt vmcnt(5)
    s_cmp_ge_i32 s27, -48
    s_cbranch_scc1 L_hi91
    s_waitcnt vmcnt(4)
L_hi91:
    s_add_u32 s10, s14, 176128
    buffer_load_dwordx4 v[212:215], v2, s[44:47], s10 offen nt
    v_mov_b32 v254, 91
    ds_write_b32 v8, v254 offset:16384
    v_and_b32 v28, v67, v12
    v_and_b32 v29, v67, v13
    v_and_b32_dpp v30, v67, v14 row_ror:8 row_mask:0xf bank_mask:0xf
    v_and_b32_dpp v31, v67, v15 row_ror:8 row_mask:0xf bank_mask:0xf
    s_nop 1
    v_mfma_f32_16x16x32_bf16 v[24:27], v[116:119], v[28:31], v[24:27]
    v_and_b32_dpp v32, v67, v12 row_ror:8 row_mask:0xf bank_mask:0xf
    v_and_b32_dpp v33, v67, v13 row_ror:8 row_mask:0xf bank_mask:0xf
    v_and_b32 v34, v67, v14
    v_and_b32 v35, v67, v15
    s_nop 1
    v_mfma_f32_16x16x32_bf16 v[24:27], v[120:123], v[32:35], v[24:27]
    s_waitcnt vmcnt(7)
    s_cmp_ge_i32 s27, 128
    s_cbranch_scc1 L_hi92
    s_waitcnt vmcnt(6)
    s_cmp_ge_i32 s27, 48
    s_cbranch_scc1 L_hi92
    s_waitcnt vmcnt(5)
    s_cmp_ge_i32 s27, -48
    s_cbranch_scc1 L_hi92
    s_waitcnt vmcnt(4)
L_hi92:
    s_add_u32 s10, s14, 180224
    buffer_load_dwordx4 v[216:219], v2, s[44:47], s10 offen nt
    v_mov_b32 v254, 92
    ds_write_b32 v8, v254 offset:16384
    ds_read_b32 v252, v253 offset:4
    v_and_b32 v28, v96, v12
    v_and_b32 v29, v96, v13
    v_and_b32_dpp v30, v96, v14 row_ror:8 row_mask:0xf bank_mask:0xf
    v_and_b32_dpp v31, v96, v15 row_ror:8 row_mask:0xf bank_mask:0xf
    s_nop 1
    v_mfma_f32_16x16x32_bf16 v[24:27], v[124:127], v[28:31], v[24:27]
    v_and_b32_dpp v32, v96, v12 row_ror:8 row_mask:0xf bank_mask:0xf
    v_and_b32_dpp v33, v96, v13 row_ror:8 row_mask:0xf bank_mask:0xf
    v_and_b32 v34, v96, v14
    v_and_b32 v35, v96, v15
    s_nop 1
    v_mfma_f32_16x16x32_bf16 v[24:27], v[132:135], v[32:35], v[24:27]
    s_waitcnt vmcnt(7)
    s_waitcnt lgkmcnt(0)
    v_readfirstlane_b32 s27, v252
    s_nop 0
    s_cmp_ge_i32 s27, 128
    s_cbranch_scc1 L_hi93
    s_waitcnt vmcnt(6)
    s_cmp_ge_i32 s27, 48
    s_cbranch_scc1 L_hi93
    s_waitcnt vmcnt(5)
    s_cmp_ge_i32 s27, -48
    s_cbranch_scc1 L_hi93
    s_waitcnt vmcnt(3)
L_hi93:
    s_add_u32 s10, s14, 188416
    buffer_load_dwordx4 v[220:223], v2, s[44:47], s10 offen nt
    v_mov_b32 v254, 93
    ds_write_b32 v8, v254 offset:16384
    v_and_b32 v28, v97, v12
    v_and_b32 v29, v97, v13
    v_and_b32_dpp v30, v97, v14 row_ror:8 row_mask:0xf bank_mask:0xf
    v_and_b32_dpp v31, v97, v15 row_ror:8 row_mask:0xf bank_mask:0xf
    s_nop 1
    v_mfma_f32_16x16x32_bf16 v[24:27], v[136:139], v[28:31], v[24:27]
    v_and_b32_dpp v32, v97, v12 row_ror:8 row_mask:0xf bank_mask:0xf
    v_and_b32_dpp v33, v97, v13 row_ror:8 row_mask:0xf bank_mask:0xf
    v_and_b32 v34, v97, v14
    v_and_b32 v35, v97, v15
    s_nop 1
    v_mfma_f32_16x16x32_bf16 v[24:27], v[140:143], v[32:35], v[24:27]
    s_waitcnt vmcnt(7)
    s_cmp_ge_i32 s27, 128
    s_cbranch_scc1 L_hi94
    s_waitcnt vmcnt(6)
    s_cmp_ge_i32 s27, 48
    s_cbranch_scc1 L_hi94
    s_waitcnt vmcnt(4)
    s_cmp_ge_i32 s27, -48
    s_cbranch_scc1 L_hi94
    s_waitcnt vmcnt(3)
L_hi94:
    s_add_u32 s10, s14, 184320
    buffer_load_dwordx4 v[228:231], v2, s[44:47], s10 offen nt
    v_mov_b32 v254, 94
    ds_write_b32 v8, v254 offset:16384
    ds_read_b32 v252, v253 offset:4
    v_and_b32 v28, v98, v12
    v_and_b32 v29, v98, v13
    v_and_b32_dpp v30, v98, v14 row_ror:8 row_mask:0xf bank_mask:0xf
    v_and_b32_dpp v31, v98, v15 row_ror:8 row_mask:0xf bank_mask:0xf
    s_nop 1
    v_mfma_f32_16x16x32_bf16 v[24:27], v[144:147], v[28:31], v[24:27]
    v_and_b32_dpp v32, v98, v12 row_ror:8 row_mask:0xf bank_mask:0xf
    v_and_b32_dpp v33, v98, v13 row_ror:8 row_mask:0xf bank_mask:0xf
    v_and_b32 v34, v98, v14
    v_and_b32 v35, v98, v15
    s_nop 1
    v_mfma_f32_16x16x32_bf16 v[24:27], v[148:151], v[32:35], v[24:27]
    s_waitcnt vmcnt(7)
    s_waitcnt lgkmcnt(0)
    v_readfirstlane_b32 s27, v252
    s_nop 0
    s_cmp_ge_i32 s27, 128
    s_cbranch_scc1 L_hi95
    s_waitcnt vmcnt(5)
    s_cmp_ge_i32 s27, 48
    s_cbranch_scc1 L_hi95
    s_waitcnt vmcnt(4)
    s_cmp_ge_i32 s27, -48
    s_cbranch_scc1 L_hi95
    s_waitcnt vmcnt(3)
L_hi95:
    s_add_u32 s10, s14, 192512
    buffer_load_dwordx4 v[232:235], v2, s[44:47], s10 offen nt
    v_mov_b32 v254, 95
    ds_write_b32 v8, v254 offset:16384
    v_and_b32 v28, v99, v12
    v_and_b32 v29, v99, v13
    v_and_b32_dpp v30, v99, v14 row_ror:8 row_mask:0xf bank_mask:0xf
    v_and_b32_dpp v31, v99, v15 row_ror:8 row_mask:0xf bank_mask:0xf
    s_nop 1
    v_mfma_f32_16x16x32_bf16 v[24:27], v[152:155], v[28:31], v[24:27]
    v_and_b32_dpp v32, v99, v12 row_ror:8 row_mask:0xf bank_mask:0xf
    v_and_b32_dpp v33, v99, v13 row_ror:8 row_mask:0xf bank_mask:0xf
    v_and_b32 v34, v99, v14
    v_and_b32 v35, v99, v15
    s_nop 1
    v_mfma_f32_16x16x32_bf16 v[24:27], v[156:159], v[32:35], v[24:27]
    s_waitcnt vmcnt(6)
    s_cmp_ge_i32 s27, 128
    s_cbranch_scc1 L_hi96
    s_waitcnt vmcnt(5)
    s_cmp_ge_i32 s27, 48
    s_cbranch_scc1 L_hi96
    s_waitcnt vmcnt(4)
    s_cmp_ge_i32 s27, -48
    s_cbranch_scc1 L_hi96
    s_waitcnt vmcnt(3)
L_hi96:
    s_add_u32 s10, s14, 262144
    buffer_load_dwordx4 v[236:239], v2, s[44:47], s10 offen nt
    v_mov_b32 v254, 96
    ds_write_b32 v8, v254 offset:16384
    ds_read_b32 v252, v253 offset:4
    v_and_b32 v28, v128, v12
    v_and_b32 v29, v128, v13
    v_and_b32_dpp v30, v128, v14 row_ror:8 row_mask:0xf bank_mask:0xf
    v_and_b32_dpp v31, v128, v15 row_ror:8 row_mask:0xf bank_mask:0xf
    s_nop 1
    v_mfma_f32_16x16x32_bf16 v[24:27], v[164:167], v[28:31], v[24:27]
    v_and_b32_dpp v32, v128, v12 row_ror:8 row_mask:0xf bank_mask:0xf
    v_and_b32_dpp v33, v128, v13 row_ror:8 row_mask:0xf bank_mask:0xf
    v_and_b32 v34, v128, v14
    v_and_b32 v35, v128, v15
    s_nop 1
    v_mfma_f32_16x16x32_bf16 v[24:27], v[168:171], v[32:35], v[24:27]
    s_waitcnt vmcnt(6)
    s_waitcnt lgkmcnt(0)
    v_readfirstlane_b32 s27, v252
    s_nop 0
    s_cmp_ge_i32 s27, 128
    s_cbranch_scc1 L_hi97
    s_waitcnt vmcnt(5)
    s_cmp_ge_i32 s27, 48
    s_cbranch_scc1 L_hi97
    s_waitcnt vmcnt(4)
    s_cmp_ge_i32 s27, -48
    s_cbranch_scc1 L_hi97
    s_waitcnt vmcnt(3)
L_hi97:
    s_add_u32 s10, s14, 270336
    buffer_load_dwordx4 v[240:243], v2, s[44:47], s10 offen nt
    v_mov_b32 v254, 97
    ds_write_b32 v8, v254 offset:16384
    v_and_b32 v28, v129, v12
    v_and_b32 v29, v129, v13
    v_and_b32_dpp v30, v129, v14 row_ror:8 row_mask:0xf bank_mask:0xf
    v_and_b32_dpp v31, v129, v15 row_ror:8 row_mask:0xf bank_mask:0xf
    s_nop 1
    v_mfma_f32_16x16x32_bf16 v[24:27], v[172:175], v[28:31], v[24:27]
    v_and_b32_dpp v32, v129, v12 row_ror:8 row_mask:0xf bank_mask:0xf
    v_and_b32_dpp v33, v129, v13 row_ror:8 row_mask:0xf bank_mask:0xf
    v_and_b32 v34, v129, v14
    v_and_b32 v35, v129, v15
    s_nop 1
    v_mfma_f32_16x16x32_bf16 v[24:27], v[176:179], v[32:35], v[24:27]
    s_waitcnt vmcnt(6)
    s_cmp_ge_i32 s27, 128
    s_cbranch_scc1 L_hi98
    s_waitcnt vmcnt(5)
    s_cmp_ge_i32 s27, 48
    s_cbranch_scc1 L_hi98
    s_waitcnt vmcnt(4)
    s_cmp_ge_i32 s27, -48
    s_cbranch_scc1 L_hi98
    s_waitcnt vmcnt(3)
L_hi98:
    s_add_u32 s10, s14, 266240
    buffer_load_dwordx4 v[36:39], v2, s[44:47], s10 offen nt
    v_mov_b32 v254, 98
    ds_write_b32 v8, v254 offset:16384
    ds_read_b32 v252, v253 offset:4
    v_and_b32 v28, v130, v12
    v_and_b32 v29, v130, v13
    v_and_b32_dpp v30, v130, v14 row_ror:8 row_mask:0xf bank_mask:0xf
    v_and_b32_dpp v31, v130, v15 row_ror:8 row_mask:0xf bank_mask:0xf
    s_nop 1
    v_mfma_f32_16x16x32_bf16 v[24:27], v[180:183], v[28:31], v[24:27]
    v_and_b32_dpp v32, v130, v12 row_ror:8 row_mask:0xf bank_mask:0xf
    v_and_b32_dpp v33, v130, v13 row_ror:8 row_mask:0xf bank_mask:0xf
    v_and_b32 v34, v130, v14
    v_and_b32 v35, v130, v15
    s_nop 1
    v_mfma_f32_16x16x32_bf16 v[24:27], v[184:187], v[32:35], v[24:27]
    s_waitcnt vmcnt(6)
    s_waitcnt lgkmcnt(0)
    v_readfirstlane_b32 s27, v252
    s_nop 0
    s_cmp_ge_i32 s27, 128
    s_cbranch_scc1 L_hi99
    s_waitcnt vmcnt(5)
    s_cmp_ge_i32 s27, 48
    s_cbranch_scc1 L_hi99
    s_waitcnt vmcnt(4)
    s_cmp_ge_i32 s27, -48
    s_cbranch_scc1 L_hi99
    s_waitcnt vmcnt(3)
L_hi99:
    s_add_u32 s10, s14, 274432
    buffer_load_dwordx4 v[40:43], v2, s[44:47], s10 offen nt
    v_mov_b32 v254, 99
    ds_write_b32 v8, v254 offset:16384
    v_and_b32 v28, v131, v12
    v_and_b32 v29, v131, v13
    v_and_b32_dpp v30, v131, v14 row_ror:8 row_mask:0xf bank_mask:0xf
    v_and_b32_dpp v31, v131, v15 row_ror:8 row_mask:0xf bank_mask:0xf
    buffer_load_dwordx2 v[10:11], v9, s[52:55], s73 offen sc1
    s_nop 0
    v_mfma_f32_16x16x32_bf16 v[24:27], v[188:191], v[28:31], v[24:27]
    v_and_b32_dpp v32, v131, v12 row_ror:8 row_mask:0xf bank_mask:0xf
    v_and_b32_dpp v33, v131, v13 row_ror:8 row_mask:0xf bank_mask:0xf
    v_and_b32 v34, v131, v14
    v_and_b32 v35, v131, v15
    s_nop 1
    v_mfma_f32_16x16x32_bf16 v[24:27], v[196:199], v[32:35], v[24:27]
    s_waitcnt vmcnt(7)
    s_cmp_ge_i32 s27, 128
    s_cbranch_scc1 L_hi100
    s_waitcnt vmcnt(6)
    s_cmp_ge_i32 s27, 48
    s_cbranch_scc1 L_hi100
    s_waitcnt vmcnt(5)
    s_cmp_ge_i32 s27, -48
    s_cbranch_scc1 L_hi100
    s_waitcnt vmcnt(4)
L_hi100:
    s_add_u32 s10, s14, 278528
    buffer_load_dwordx4 v[44:47], v2, s[44:47], s10 offen nt
    v_mov_b32 v254, 100
    ds_write_b32 v8, v254 offset:16384
    ds_read_b32 v252, v253 offset:4
    v_and_b32 v28, v160, v12
    v_and_b32 v29, v160, v13
    v_and_b32_dpp v30, v160, v14 row_ror:8 row_mask:0xf bank_mask:0xf
    v_and_b32_dpp v31, v160, v15 row_ror:8 row_mask:0xf bank_mask:0xf
    s_nop 1
    v_mfma_f32_16x16x32_bf16 v[24:27], v[200:203], v[28:31], v[24:27]
    v_and_b32_dpp v32, v160, v12 row_ror:8 row_mask:0xf bank_mask:0xf
    v_and_b32_dpp v33, v160, v13 row_ror:8 row_mask:0xf bank_mask:0xf
    v_and_b32 v34, v160, v14
    v_and_b32 v35, v160, v15
    s_nop 1
    v_mfma_f32_16x16x32_bf16 v[24:27], v[204:207], v[32:35], v[24:27]
    s_waitcnt vmcnt(7)
    s_waitcnt lgkmcnt(0)
    v_readfirstlane_b32 s27, v252
    s_nop 0
    s_cmp_ge_i32 s27, 128
    s_cbranch_scc1 L_hi101
    s_waitcnt vmcnt(6)
    s_cmp_ge_i32 s27, 48
    s_cbranch_scc1 L_hi101
    s_waitcnt vmcnt(5)
    s_cmp_ge_i32 s27, -48
    s_cbranch_scc1 L_hi101
    s_waitcnt vmcnt(4)
L_hi101:
    s_add_u32 s10, s14, 286720
    buffer_load_dwordx4 v[52:55], v2, s[44:47], s10 offen nt
    v_mov_b32 v254, 101
    ds_write_b32 v8, v254 offset:16384
    v_and_b32 v28, v161, v12
    v_and_b32 v29, v161, v13
    v_and_b32_dpp v30, v161, v14 row_ror:8 row_mask:0xf bank_mask:0xf
    v_and_b32_dpp v31, v161, v15 row_ror:8 row_mask:0xf bank_mask:0xf
    s_nop 1
    v_mfma_f32_16x16x32_bf16 v[24:27], v[208:211], v[28:31], v[24:27]
    v_and_b32_dpp v32, v161, v12 row_ror:8 row_mask:0xf bank_mask:0xf
    v_and_b32_dpp v33, v161, v13 row_ror:8 row_mask:0xf bank_mask:0xf
    v_and_b32 v34, v161, v14
    v_and_b32 v35, v161, v15
    s_nop 1
    v_mfma_f32_16x16x32_bf16 v[24:27], v[212:215], v[32:35], v[24:27]
    s_waitcnt vmcnt(7)
    s_cmp_ge_i32 s27, 128
    s_cbranch_scc1 L_hi102
    s_waitcnt vmcnt(6)
    s_cmp_ge_i32 s27, 48
    s_cbranch_scc1 L_hi102
    s_waitcnt vmcnt(5)
    s_cmp_ge_i32 s27, -48
    s_cbranch_scc1 L_hi102
    s_waitcnt vmcnt(4)
L_hi102:
    s_add_u32 s10, s14, 282624
    buffer_load_dwordx4 v[56:59], v2, s[44:47], s10 offen nt
    v_mov_b32 v254, 102
    ds_write_b32 v8, v254 offset:16384
    ds_read_b32 v252, v253 offset:4
    v_and_b32 v28, v162, v12
    v_and_b32 v29, v162, v13
    v_and_b32_dpp v30, v162, v14 row_ror:8 row_mask:0xf bank_mask:0xf
    v_and_b32_dpp v31, v162, v15 row_ror:8 row_mask:0xf bank_mask:0xf
    s_nop 1
    v_mfma_f32_16x16x32_bf16 v[24:27], v[216:219], v[28:31], v[24:27]
    v_and_b32_dpp v32, v162, v12 row_ror:8 row_mask:0xf bank_mask:0xf
    v_and_b32_dpp v33, v162, v13 row_ror:8 row_mask:0xf bank_mask:0xf
    v_and_b32 v34, v162, v14
    v_and_b32 v35, v162, v15
    s_nop 1
    v_mfma_f32_16x16x32_bf16 v[24:27], v[220:223], v[32:35], v[24:27]
    s_waitcnt vmcnt(7)
    s_waitcnt lgkmcnt(0)
    v_readfirstlane_b32 s27, v252
    s_nop 0
    s_cmp_ge_i32 s27, 128
    s_cbranch_scc1 L_hi103
    s_waitcnt vmcnt(6)
    s_cmp_ge_i32 s27, 48
    s_cbranch_scc1 L_hi103
    s_waitcnt vmcnt(5)
    s_cmp_ge_i32 s27, -48
    s_cbranch_scc1 L_hi103
    s_waitcnt vmcnt(4)
L_hi103:
    s_add_u32 s10, s14, 290816
    buffer_load_dwordx4 v[60:63], v2, s[44:47], s10 offen nt
    v_mov_b32 v254, 103
    ds_write_b32 v8, v254 offset:16384
    v_and_b32 v28, v163, v12
    v_and_b32 v29, v163, v13
    v_and_b32_dpp v30, v163, v14 row_ror:8 row_mask:0xf bank_mask:0xf
    v_and_b32_dpp v31, v163, v15 row_ror:8 row_mask:0xf bank_mask:0xf
    s_nop 1
    v_mfma_f32_16x16x32_bf16 v[24:27], v[228:231], v[28:31], v[24:27]
    v_and_b32_dpp v32, v163, v12 row_ror:8 row_mask:0xf bank_mask:0xf
    v_and_b32_dpp v33, v163, v13 row_ror:8 row_mask:0xf bank_mask:0xf
    v_and_b32 v34, v163, v14
    v_and_b32 v35, v163, v15
    s_nop 1
    v_mfma_f32_16x16x32_bf16 v[24:27], v[232:235], v[32:35], v[24:27]
    s_waitcnt vmcnt(7)
    s_cmp_ge_i32 s27, 128
    s_cbranch_scc1 L_hi104
    s_waitcnt vmcnt(6)
    s_cmp_ge_i32 s27, 48
    s_cbranch_scc1 L_hi104
    s_waitcnt vmcnt(5)
    s_cmp_ge_i32 s27, -48
    s_cbranch_scc1 L_hi104
    s_waitcnt vmcnt(3)
L_hi104:
    s_add_u32 s10, s14, 294912
    buffer_load_dwordx4 v[68:71], v2, s[44:47], s10 offen nt
    v_mov_b32 v254, 104
    ds_write_b32 v8, v254 offset:16384
    ds_read_b32 v252, v253 offset:4
    v_and_b32 v28, v192, v12
    v_and_b32 v29, v192, v13
    v_and_b32_dpp v30, v192, v14 row_ror:8 row_mask:0xf bank_mask:0xf
    v_and_b32_dpp v31, v192, v15 row_ror:8 row_mask:0xf bank_mask:0xf
    s_nop 1
    v_mfma_f32_16x16x32_bf16 v[24:27], v[236:239], v[28:31], v[24:27]
    v_and_b32_dpp v32, v192, v12 row_ror:8 row_mask:0xf bank_mask:0xf
    v_and_b32_dpp v33, v192, v13 row_ror:8 row_mask:0xf bank_mask:0xf
    v_and_b32 v34, v192, v14
    v_and_b32 v35, v192, v15
    s_nop 1
    v_mfma_f32_16x16x32_bf16 v[24:27], v[240:243], v[32:35], v[24:27]
    s_waitcnt vmcnt(7)
    s_waitcnt lgkmcnt(0)
    v_readfirstlane_b32 s27, v252
    s_nop 0
    s_cmp_ge_i32 s27, 128
    s_cbranch_scc1 L_hi105
    s_waitcnt vmcnt(6)
    s_cmp_ge_i32 s27, 48
    s_cbranch_scc1 L_hi105
    s_waitcnt vmcnt(4)
    s_cmp_ge_i32 s27, -48
    s_cbranch_scc1 L_hi105
    s_waitcnt vmcnt(3)
L_hi105:
    s_add_u32 s10, s14, 303104
    buffer_load_dwordx4 v[72:75], v2, s[44:47], s10 offen nt
    v_mov_b32 v254, 105
    ds_write_b32 v8, v254 offset:16384
    v_and_b32 v28, v193, v12
    v_and_b32 v29, v193, v13
    v_and_b32_dpp v30, v193, v14 row_ror:8 row_mask:0xf bank_mask:0xf
    v_and_b32_dpp v31, v193, v15 row_ror:8 row_mask:0xf bank_mask:0xf
    s_nop 1
    v_mfma_f32_16x16x32_bf16 v[24:27], v[36:39], v[28:31], v[24:27]
    v_and_b32_dpp v32, v193, v12 row_ror:8 row_mask:0xf bank_mask:0xf
    v_and_b32_dpp v33, v193, v13 row_ror:8 row_mask:0xf bank_mask:0xf
    v_and_b32 v34, v193, v14
    v_and_b32 v35, v193, v15
    s_waitcnt vmcnt(7)
    s_nop 0
    v_mfma_f32_16x16x32_bf16 v[24:27], v[40:43], v[32:35], v[24:27]
    v_and_b32 v28, v194, v12
    v_and_b32 v29, v194, v13
    v_and_b32_dpp v30, v194, v14 row_ror:8 row_mask:0xf bank_mask:0xf
    v_and_b32_dpp v31, v194, v15 row_ror:8 row_mask:0xf bank_mask:0xf
    s_cmp_ge_i32 s27, 128
    s_cbranch_scc1 L_hi106
    s_waitcnt vmcnt(5)
    s_cmp_ge_i32 s27, 48
    s_cbranch_scc1 L_hi106
    s_waitcnt vmcnt(4)
    s_cmp_ge_i32 s27, -48
    s_cbranch_scc1 L_hi106
    s_waitcnt vmcnt(3)
L_hi106:
    s_add_u32 s10, s14, 299008
    buffer_load_dwordx4 v[76:79], v2, s[44:47], s10 offen nt
    v_mov_b32 v254, 106
    ds_write_b32 v8, v254 offset:16384
    ds_read_b32 v252, v253 offset:4
    s_waitcnt vmcnt(6)
    v_mfma_f32_16x16x32_bf16 v[24:27], v[44:47], v[28:31], v[24:27]
    v_and_b32_dpp v32, v194, v12 row_ror:8 row_mask:0xf bank_mask:0xf
    v_and_b32_dpp v33, v194, v13 row_ror:8 row_mask:0xf bank_mask:0xf
    v_and_b32 v34, v194, v14
    v_and_b32 v35, v194, v15
    v_max_u32 v3, v10, v11
    v_cmp_ne_u32 vcc, -1, v3
    s_nop 0
    s_cmp_eq_u64 vcc, exec
    s_cbranch_scc1 L_stat_ok
    s_mov_b32 s11, 400000
L_stat:
    buffer_load_dwordx2 v[10:11], v9, s[52:55], s73 offen sc1
    s_waitcnt vmcnt(0)
    v_max_u32 v3, v10, v11
    v_cmp_ne_u32 vcc, -1, v3
    s_nop 0
    s_cmp_eq_u64 vcc, exec
    s_cbranch_scc1 L_stat_ok
    s_sub_u32 s11, s11, 1
    s_cmp_lg_u32 s11, 0
    s_cbranch_scc1 L_stat
L_stat_ok:
    v_mov_b32 v7, v10
    s_nop 1
    v_max_f32_dpp v7, v7, v7 row_ror:8 row_mask:0xf bank_mask:0xf
    v_mov_b32 v3, v7
    s_nop 1
    v_permlane16_swap_b32 v7, v3
    v_max_f32 v7, v7, v3
    v_mov_b32 v3, v7
    s_nop 1
    v_permlane32_swap_b32 v7, v3
    v_max_f32 v7, v7, v3
    v_sub_f32 v10, v10, v7
    v_sub_f32 v7, v5, v7
    v_exp_f32 v10, v10
    v_exp_f32 v7, v7
    v_mul_f32 v10, v10, v11
    s_waitcnt lgkmcnt(0)
    v_readfirstlane_b32 s27, v252
    s_nop 0
    s_cmp_ge_i32 s27, 128
    s_cbranch_scc1 L_hi107
    s_waitcnt vmcnt(5)
    s_cmp_ge_i32 s27, 48
    s_cbranch_scc1 L_hi107
    s_waitcnt vmcnt(4)
    s_cmp_ge_i32 s27, -48
    s_cbranch_scc1 L_hi107
    s_waitcnt vmcnt(3)
L_hi107:
    s_add_u32 s10, s14, 307200
    buffer_load_dwordx4 v[80:83], v2, s[44:47], s10 offen nt
    v_mov_b32 v254, 107
    ds_write_b32 v8, v254 offset:16384
    v_add_f32_dpp v10, v10, v10 row_ror:8 row_mask:0xf bank_mask:0xf
    v_mov_b32 v3, v10
    s_nop 1
    v_permlane16_swap_b32 v10, v3
    v_add_f32 v10, v10, v3
    v_mov_b32 v3, v10
    s_nop 1
    v_permlane32_swap_b32 v10, v3
    v_add_f32 v10, v10, v3
    v_rcp_f32 v10, v10
    s_nop 0
    v_mul_f32 v7, v7, v10
    v_mov_b32 v6, v7
    v_bfe_u32 v3, v0, 2, 1
    v_mul_u32_u24 v9, 704, v3
    v_lshrrev_b32 v4, 4, v0
    v_mul_u32_u24 v4, 160, v4
    v_add_u32 v9, v9, v4
    v_bfe_u32 v3, v0, 3, 1
    v_lshl_add_u32 v9, v3, 4, v9
    v_and_b32 v3, 3, v0
    v_lshl_add_u32 v9, v3, 2, v9
    s_mul_i32 s4, s3, 1536
    s_add_u32 s4, s4, 2048
    v_add_u32 v9, s4, v9
    s_lshr_b32 s4, s3, 1
    s_mul_i32 s4, s4, 704
    s_and_b32 s5, s3, 1
    s_mul_i32 s5, s5, 320
    s_add_u32 s4, s4, s5
    v_and_b32 v3, 15, v0
    v_lshl_add_u32 v10, v3, 3, v4
    v_add_u32 v10, s4, v10
    v_lshlrev_b32 v11, 2, v0
    v_lshlrev_b32 v11, 2, v3
    v_lshrrev_b32 v3, 4, v0
    v_lshl_or_b32 v11, v3, 10, v11
    s_waitcnt vmcnt(6)
    v_mfma_f32_16x16x32_bf16 v[24:27], v[52:55], v[32:35], v[24:27]
    v_and_b32 v28, v195, v12
    v_and_b32 v29, v195, v13
    v_and_b32_dpp v30, v195, v14 row_ror:8 row_mask:0xf bank_mask:0xf
    v_and_b32_dpp v31, v195, v15 row_ror:8 row_mask:0xf bank_mask:0xf
    s_cmp_ge_i32 s27, 128
    s_cbranch_scc1 L_hi108
    s_waitcnt vmcnt(5)
    s_cmp_ge_i32 s27, 48
    s_cbranch_scc1 L_hi108
    s_waitcnt vmcnt(4)
    s_cmp_ge_i32 s27, -48
    s_cbranch_scc1 L_hi108
    s_waitcnt vmcnt(3)
L_hi108:
    s_add_u32 s10, s14, 311296
    buffer_load_dwordx4 v[248:251], v2, s[44:47], s10 offen nt
    v_mov_b32 v254, 108
    ds_write_b32 v8, v254 offset:16384
    ds_read_b32 v252, v253 offset:4
    s_waitcnt vmcnt(6)
    v_mfma_f32_16x16x32_bf16 v[24:27], v[56:59], v[28:31], v[24:27]
    v_and_b32_dpp v32, v195, v12 row_ror:8 row_mask:0xf bank_mask:0xf
    v_and_b32_dpp v33, v195, v13 row_ror:8 row_mask:0xf bank_mask:0xf
    v_and_b32 v34, v195, v14
    v_and_b32 v35, v195, v15
    s_waitcnt lgkmcnt(0)
    v_readfirstlane_b32 s27, v252
    s_nop 0
    s_cmp_ge_i32 s27, 128
    s_cbranch_scc1 L_hi109
    s_waitcnt vmcnt(5)
    s_cmp_ge_i32 s27, 48
    s_cbranch_scc1 L_hi109
    s_waitcnt vmcnt(4)
    s_cmp_ge_i32 s27, -48
    s_cbranch_scc1 L_hi109
    s_waitcnt vmcnt(3)
L_hi109:
    s_add_u32 s10, s14, 319488
    buffer_load_dwordx4 v[244:247], v2, s[44:47], s10 offen nt
    v_mov_b32 v254, 109
    ds_write_b32 v8, v254 offset:16384
    s_waitcnt vmcnt(6)
    v_mfma_f32_16x16x32_bf16 v[24:27], v[60:63], v[32:35], v[24:27]
    v_and_b32 v28, v224, v12
    v_and_b32 v29, v224, v13
    v_and_b32_dpp v30, v224, v14 row_ror:8 row_mask:0xf bank_mask:0xf
    v_and_b32_dpp v31, v224, v15 row_ror:8 row_mask:0xf bank_mask:0xf
    s_cmp_ge_i32 s27, 128
    s_cbranch_scc1 L_hi110
    s_waitcnt vmcnt(5)
    s_cmp_ge_i32 s27, 48
    s_cbranch_scc1 L_hi110
    s_waitcnt vmcnt(4)
    s_cmp_ge_i32 s27, -48
    s_cbranch_scc1 L_hi110
    s_waitcnt vmcnt(3)
L_hi110:
    s_add_u32 s10, s14, 315392
    buffer_load_dwordx4 v[88:91], v2, s[44:47], s10 offen nt
    v_mov_b32 v254, 110
    ds_write_b32 v8, v254 offset:16384
    ds_read_b32 v252, v253 offset:4
    s_waitcnt vmcnt(6)
    v_mfma_f32_16x16x32_bf16 v[24:27], v[68:71], v[28:31], v[24:27]
    v_and_b32_dpp v32, v224, v12 row_ror:8 row_mask:0xf bank_mask:0xf
    v_and_b32_dpp v33, v224, v13 row_ror:8 row_mask:0xf bank_mask:0xf
    v_and_b32 v34, v224, v14
    v_and_b32 v35, v224, v15
    s_waitcnt lgkmcnt(0)
    v_readfirstlane_b32 s27, v252
    s_nop 0
    s_cmp_ge_i32 s27, 128
    s_cbranch_scc1 L_hi111
    s_waitcnt vmcnt(5)
    s_cmp_ge_i32 s27, 48
    s_cbranch_scc1 L_hi111
    s_waitcnt vmcnt(4)
    s_cmp_ge_i32 s27, -48
    s_cbranch_scc1 L_hi111
    s_waitcnt vmcnt(3)
L_hi111:
    s_add_u32 s10, s14, 323584
    buffer_load_dwordx4 v[92:95], v2, s[44:47], s10 offen nt
    v_mov_b32 v254, 111
    ds_write_b32 v8, v254 offset:16384
    s_waitcnt vmcnt(6)
    v_mfma_f32_16x16x32_bf16 v[24:27], v[72:75], v[32:35], v[24:27]
    v_and_b32 v28, v225, v12
    v_and_b32 v29, v225, v13
    v_and_b32_dpp v30, v225, v14 row_ror:8 row_mask:0xf bank_mask:0xf
    v_and_b32_dpp v31, v225, v15 row_ror:8 row_mask:0xf bank_mask:0xf
    s_cmp_ge_i32 s27, 128
    s_cbranch_scc1 L_hi112
    s_waitcnt vmcnt(5)
    s_cmp_ge_i32 s27, 48
    s_cbranch_scc1 L_hi112
    s_waitcnt vmcnt(4)
    s_cmp_ge_i32 s27, -48
    s_cbranch_scc1 L_hi112
    s_waitcnt vmcnt(3)
L_hi112:
    s_add_u32 s10, s14, 393216
    buffer_load_dwordx4 v[100:103], v2, s[44:47], s10 offen nt
    v_mov_b32 v254, 112
    ds_write_b32 v8, v254 offset:16384
    ds_read_b32 v252, v253 offset:4
    s_waitcnt vmcnt(6)
    v_mfma_f32_16x16x32_bf16 v[24:27], v[76:79], v[28:31], v[24:27]
    v_and_b32_dpp v32, v225, v12 row_ror:8 row_mask:0xf bank_mask:0xf
    v_and_b32_dpp v33, v225, v13 row_ror:8 row_mask:0xf bank_mask:0xf
    v_and_b32 v34, v225, v14
    v_and_b32 v35, v225, v15
    s_waitcnt lgkmcnt(0)
    v_readfirstlane_b32 s27, v252
    s_nop 0
    s_cmp_ge_i32 s27, 128
    s_cbranch_scc1 L_hi113
    s_waitcnt vmcnt(5)
    s_cmp_ge_i32 s27, 48
    s_cbranch_scc1 L_hi113
    s_waitcnt vmcnt(4)
    s_cmp_ge_i32 s27, -48
    s_cbranch_scc1 L_hi113
    s_waitcnt vmcnt(3)
L_hi113:
    s_add_u32 s10, s14, 401408
    buffer_load_dwordx4 v[104:107], v2, s[44:47], s10 offen nt
    v_mov_b32 v254, 113
    ds_write_b32 v8, v254 offset:16384
    s_waitcnt vmcnt(6)
    v_mfma_f32_16x16x32_bf16 v[24:27], v[80:83], v[32:35], v[24:27]
    v_and_b32 v28, v226, v12
    v_and_b32 v29, v226, v13
    v_and_b32_dpp v30, v226, v14 row_ror:8 row_mask:0xf bank_mask:0xf
    v_and_b32_dpp v31, v226, v15 row_ror:8 row_mask:0xf bank_mask:0xf
    s_cmp_ge_i32 s27, 128
    s_cbranch_scc1 L_hi114
    s_waitcnt vmcnt(5)
    s_cmp_ge_i32 s27, 48
    s_cbranch_scc1 L_hi114
    s_waitcnt vmcnt(4)
    s_cmp_ge_i32 s27, -48
    s_cbranch_scc1 L_hi114
    s_waitcnt vmcnt(3)
L_hi114:
    s_add_u32 s10, s14, 397312
    buffer_load_dwordx4 v[108:111], v2, s[44:47], s10 offen nt
    v_mov_b32 v254, 114
    ds_write_b32 v8, v254 offset:16384
    ds_read_b32 v252, v253 offset:4
    s_waitcnt vmcnt(6)
    v_mfma_f32_16x16x32_bf16 v[24:27], v[248:251], v[28:31], v[24:27]
    v_and_b32_dpp v32, v226, v12 row_ror:8 row_mask:0xf bank_mask:0xf
    v_and_b32_dpp v33, v226, v13 row_ror:8 row_mask:0xf bank_mask:0xf
    v_and_b32 v34, v226, v14
    v_and_b32 v35, v226, v15
    s_waitcnt lgkmcnt(0)
    v_readfirstlane_b32 s27, v252
    s_nop 0
    s_cmp_ge_i32 s27, 128
    s_cbranch_scc1 L_hi115
    s_waitcnt vmcnt(5)
    s_cmp_ge_i32 s27, 48
    s_cbranch_scc1 L_hi115
    s_waitcnt vmcnt(4)
    s_cmp_ge_i32 s27, -48
    s_cbranch_scc1 L_hi115
    s_waitcnt vmcnt(3)
L_hi115:
    s_add_u32 s10, s14, 405504
    buffer_load_dwordx4 v[112:115], v2, s[44:47], s10 offen nt
    v_mov_b32 v254, 115
    ds_write_b32 v8, v254 offset:16384
    s_waitcnt vmcnt(6)
    v_mfma_f32_16x16x32_bf16 v[24:27], v[244:247], v[32:35], v[24:27]
    v_and_b32 v28, v227, v12
    v_and_b32 v29, v227, v13
    v_and_b32_dpp v30, v227, v14 row_ror:8 row_mask:0xf bank_mask:0xf
    v_and_b32_dpp v31, v227, v15 row_ror:8 row_mask:0xf bank_mask:0xf
    s_cmp_ge_i32 s27, 128
    s_cbranch_scc1 L_hi116
    s_waitcnt vmcnt(5)
    s_cmp_ge_i32 s27, 48
    s_cbranch_scc1 L_hi116
    s_waitcnt vmcnt(4)
    s_cmp_ge_i32 s27, -48
    s_cbranch_scc1 L_hi116
    s_waitcnt vmcnt(3)
L_hi116:
    s_add_u32 s10, s14, 409600
    buffer_load_dwordx4 v[116:119], v2, s[44:47], s10 offen nt
    v_mov_b32 v254, 116
    ds_write_b32 v8, v254 offset:16384
    ds_read_b32 v252, v253 offset:4
    s_waitcnt vmcnt(6)
    v_mfma_f32_16x16x32_bf16 v[24:27], v[88:91], v[28:31], v[24:27]
    v_and_b32_dpp v32, v227, v12 row_ror:8 row_mask:0xf bank_mask:0xf
    v_and_b32_dpp v33, v227, v13 row_ror:8 row_mask:0xf bank_mask:0xf
    v_and_b32 v34, v227, v14
    v_and_b32 v35, v227, v15
    s_waitcnt lgkmcnt(0)
    v_readfirstlane_b32 s27, v252
    s_nop 0
    s_cmp_ge_i32 s27, 128
    s_cbranch_scc1 L_hi117
    s_waitcnt vmcnt(5)
    s_cmp_ge_i32 s27, 48
    s_cbranch_scc1 L_hi117
    s_waitcnt vmcnt(4)
    s_cmp_ge_i32 s27, -48
    s_cbranch_scc1 L_hi117
    s_waitcnt vmcnt(3)
L_hi117:
    s_add_u32 s10, s14, 417792
    buffer_load_dwordx4 v[120:123], v2, s[44:47], s10 offen nt
    v_mov_b32 v254, 117
    ds_write_b32 v8, v254 offset:16384
    s_waitcnt vmcnt(6)
    v_mfma_f32_16x16x32_bf16 v[24:27], v[92:95], v[32:35], v[24:27]
    v_and_b32 v28, v48, v12
    v_and_b32 v29, v48, v13
    v_and_b32_dpp v30, v48, v14 row_ror:8 row_mask:0xf bank_mask:0xf
    v_and_b32_dpp v31, v48, v15 row_ror:8 row_mask:0xf bank_mask:0xf
    s_cmp_ge_i32 s27, 128
    s_cbranch_scc1 L_hi118
    s_waitcnt vmcnt(5)
    s_cmp_ge_i32 s27, 48
    s_cbranch_scc1 L_hi118
    s_waitcnt vmcnt(4)
    s_cmp_ge_i32 s27, -48
    s_cbranch_scc1 L_hi118
    s_waitcnt vmcnt(3)
L_hi118:
    s_add_u32 s10, s14, 413696
    buffer_load_dwordx4 v[124:127], v2, s[44:47], s10 offen nt
    v_mov_b32 v254, 118
    ds_write_b32 v8, v254 offset:16384
    ds_read_b32 v252, v253 offset:4
    s_waitcnt vmcnt(6)
    v_mfma_f32_16x16x32_bf16 v[24:27], v[100:103], v[28:31], v[24:27]
    v_and_b32_dpp v32, v48, v12 row_ror:8 row_mask:0xf bank_mask:0xf
    v_and_b32_dpp v33, v48, v13 row_ror:8 row_mask:0xf bank_mask:0xf
    v_and_b32 v34, v48, v14
    v_and_b32 v35, v48, v15
    s_waitcnt lgkmcnt(0)
    v_readfirstlane_b32 s27, v252
    s_nop 0
    s_cmp_ge_i32 s27, 128
    s_cbranch_scc1 L_hi119
    s_waitcnt vmcnt(5)
    s_cmp_ge_i32 s27, 48
    s_cbranch_scc1 L_hi119
    s_waitcnt vmcnt(4)
    s_cmp_ge_i32 s27, -48
    s_cbranch_scc1 L_hi119
    s_waitcnt vmcnt(3)
L_hi119:
    s_add_u32 s10, s14, 421888
    buffer_load_dwordx4 v[132:135], v2, s[44:47], s10 offen nt
    v_mov_b32 v254, 119
    ds_write_b32 v8, v254 offset:16384
    s_waitcnt vmcnt(6)
    v_mfma_f32_16x16x32_bf16 v[24:27], v[104:107], v[32:35], v[24:27]
    v_and_b32 v28, v49, v12
    v_and_b32 v29, v49, v13
    v_and_b32_dpp v30, v49, v14 row_ror:8 row_mask:0xf bank_mask:0xf
    v_and_b32_dpp v31, v49, v15 row_ror:8 row_mask:0xf bank_mask:0xf
    s_cmp_ge_i32 s27, 128
    s_cbranch_scc1 L_hi120
    s_waitcnt vmcnt(5)
    s_cmp_ge_i32 s27, 48
    s_cbranch_scc1 L_hi120
    s_waitcnt vmcnt(4)
    s_cmp_ge_i32 s27, -48
    s_cbranch_scc1 L_hi120
    s_waitcnt vmcnt(3)
L_hi120:
    s_add_u32 s10, s14, 425984
    buffer_load_dwordx4 v[136:139], v2, s[44:47], s10 offen nt
    v_mov_b32 v254, 120
    ds_write_b32 v8, v254 offset:16384
    ds_read_b32 v252, v253 offset:4
    s_waitcnt lgkmcnt(0)
    v_readfirstlane_b32 s27, v252
    s_nop 0
    s_cmp_ge_i32 s27, 128
    s_cbranch_scc1 L_hi121
    s_waitcnt vmcnt(6)
    s_cmp_ge_i32 s27, 48
    s_cbranch_scc1 L_hi121
    s_waitcnt vmcnt(5)
    s_cmp_ge_i32 s27, -48
    s_cbranch_scc1 L_hi121
    s_waitcnt vmcnt(4)
L_hi121:
    s_add_u32 s10, s14, 434176
    buffer_load_dwordx4 v[140:143], v2, s[44:47], s10 offen nt
    v_mov_b32 v254, 121
    ds_write_b32 v8, v254 offset:16384
    s_waitcnt vmcnt(7)
    v_mfma_f32_16x16x32_bf16 v[24:27], v[108:111], v[28:31], v[24:27]
    v_and_b32_dpp v32, v49, v12 row_ror:8 row_mask:0xf bank_mask:0xf
    v_and_b32_dpp v33, v49, v13 row_ror:8 row_mask:0xf bank_mask:0xf
    v_and_b32 v34, v49, v14
    v_and_b32 v35, v49, v15
    s_cmp_ge_i32 s27, 128
    s_cbranch_scc1 L_hi122
    s_waitcnt vmcnt(6)
    s_cmp_ge_i32 s27, 48
    s_cbranch_scc1 L_hi122
    s_waitcnt vmcnt(5)
    s_cmp_ge_i32 s27, -48
    s_cbranch_scc1 L_hi122
    s_waitcnt vmcnt(4)
L_hi122:
    s_add_u32 s10, s14, 430080
    buffer_load_dwordx4 v[144:147], v2, s[44:47], s10 offen nt
    v_mov_b32 v254, 122
    ds_write_b32 v8, v254 offset:16384
    ds_read_b32 v252, v253 offset:4
    s_waitcnt vmcnt(7)
    v_mfma_f32_16x16x32_bf16 v[24:27], v[112:115], v[32:35], v[24:27]
    v_and_b32 v28, v50, v12
    v_and_b32 v29, v50, v13
    v_and_b32_dpp v30, v50, v14 row_ror:8 row_mask:0xf bank_mask:0xf
    v_and_b32_dpp v31, v50, v15 row_ror:8 row_mask:0xf bank_mask:0xf
    s_waitcnt lgkmcnt(0)
    v_readfirstlane_b32 s27, v252
    s_nop 0
    s_cmp_ge_i32 s27, 128
    s_cbranch_scc1 L_hi123
    s_waitcnt vmcnt(6)
    s_cmp_ge_i32 s27, 48
    s_cbranch_scc1 L_hi123
    s_waitcnt vmcnt(5)
    s_cmp_ge_i32 s27, -48
    s_cbranch_scc1 L_hi123
    s_waitcnt vmcnt(4)
L_hi123:
    s_add_u32 s10, s14, 438272
    buffer_load_dwordx4 v[148:151], v2, s[44:47], s10 offen nt
    v_mov_b32 v254, 123
    ds_write_b32 v8, v254 offset:16384
    s_waitcnt vmcnt(7)
    v_mfma_f32_16x16x32_bf16 v[24:27], v[116:119], v[28:31], v[24:27]
    v_and_b32_dpp v32, v50, v12 row_ror:8 row_mask:0xf bank_mask:0xf
    v_and_b32_dpp v33, v50, v13 row_ror:8 row_mask:0xf bank_mask:0xf
    v_and_b32 v34, v50, v14
    v_and_b32 v35, v50, v15
    s_cmp_ge_i32 s27, 128
    s_cbranch_scc1 L_hi124
    s_waitcnt vmcnt(6)
    s_cmp_ge_i32 s27, 48
    s_cbranch_scc1 L_hi124
    s_waitcnt vmcnt(5)
    s_cmp_ge_i32 s27, -48
    s_cbranch_scc1 L_hi124
    s_waitcnt vmcnt(4)
L_hi124:
    s_add_u32 s10, s14, 442368
    buffer_load_dwordx4 v[152:155], v2, s[44:47], s10 offen nt
    v_mov_b32 v254, 124
    ds_write_b32 v8, v254 offset:16384
    ds_read_b32 v252, v253 offset:4
    s_waitcnt vmcnt(7)
    v_mfma_f32_16x16x32_bf16 v[24:27], v[120:123], v[32:35], v[24:27]
    v_and_b32 v28, v51, v12
    v_and_b32 v29, v51, v13
    v_and_b32_dpp v30, v51, v14 row_ror:8 row_mask:0xf bank_mask:0xf
    v_and_b32_dpp v31, v51, v15 row_ror:8 row_mask:0xf bank_mask:0xf
    s_waitcnt lgkmcnt(0)
    v_readfirstlane_b32 s27, v252
    s_nop 0
    s_cmp_ge_i32 s27, 128
    s_cbranch_scc1 L_hi125
    s_waitcnt vmcnt(6)
    s_cmp_ge_i32 s27, 48
    s_cbranch_scc1 L_hi125
    s_waitcnt vmcnt(5)
    s_cmp_ge_i32 s27, -48
    s_cbranch_scc1 L_hi125
    s_waitcnt vmcnt(4)
L_hi125:
    s_add_u32 s10, s14, 450560
    buffer_load_dwordx4 v[156:159], v2, s[44:47], s10 offen nt
    v_mov_b32 v254, 125
    ds_write_b32 v8, v254 offset:16384
    s_waitcnt vmcnt(7)
    v_mfma_f32_16x16x32_bf16 v[24:27], v[124:127], v[28:31], v[24:27]
    v_and_b32_dpp v32, v51, v12 row_ror:8 row_mask:0xf bank_mask:0xf
    v_and_b32_dpp v33, v51, v13 row_ror:8 row_mask:0xf bank_mask:0xf
    v_and_b32 v34, v51, v14
    v_and_b32 v35, v51, v15
    s_cmp_ge_i32 s27, 128
    s_cbranch_scc1 L_hi126
    s_waitcnt vmcnt(6)
    s_cmp_ge_i32 s27, 48
    s_cbranch_scc1 L_hi126
    s_waitcnt vmcnt(5)
    s_cmp_ge_i32 s27, -48
    s_cbranch_scc1 L_hi126
    s_waitcnt vmcnt(4)
L_hi126:
    s_add_u32 s10, s14, 446464
    buffer_load_dwordx4 v[164:167], v2, s[44:47], s10 offen nt
    v_mov_b32 v254, 126
    ds_write_b32 v8, v254 offset:16384
    ds_read_b32 v252, v253 offset:4
    s_waitcnt vmcnt(7)
    v_mfma_f32_16x16x32_bf16 v[24:27], v[132:135], v[32:35], v[24:27]
    v_and_b32 v28, v84, v12
    v_and_b32 v29, v84, v13
    v_and_b32_dpp v30, v84, v14 row_ror:8 row_mask:0xf bank_mask:0xf
    v_and_b32_dpp v31, v84, v15 row_ror:8 row_mask:0xf bank_mask:0xf
    s_waitcnt lgkmcnt(0)
    v_readfirstlane_b32 s27, v252
    s_nop 0
    s_cmp_ge_i32 s27, 128
    s_cbranch_scc1 L_hi127
    s_waitcnt vmcnt(6)
    s_cmp_ge_i32 s27, 48
    s_cbranch_scc1 L_hi127
    s_waitcnt vmcnt(5)
    s_cmp_ge_i32 s27, -48
    s_cbranch_scc1 L_hi127
    s_waitcnt vmcnt(4)
L_hi127:
    s_add_u32 s10, s14, 454656
    buffer_load_dwordx4 v[168:171], v2, s[44:47], s10 offen nt
    s_barrier
    v_mov_b32 v254, 127
    ds_write_b32 v8, v254 offset:16384
    s_waitcnt vmcnt(7)
    v_mfma_f32_16x16x32_bf16 v[24:27], v[136:139], v[28:31], v[24:27]
    v_and_b32_dpp v32, v84, v12 row_ror:8 row_mask:0xf bank_mask:0xf
    v_and_b32_dpp v33, v84, v13 row_ror:8 row_mask:0xf bank_mask:0xf
    v_and_b32 v34, v84, v14
    v_and_b32 v35, v84, v15
    s_waitcnt vmcnt(6)
    s_nop 0
    v_mfma_f32_16x16x32_bf16 v[24:27], v[140:143], v[32:35], v[24:27]
    v_and_b32 v28, v85, v12
    v_and_b32 v29, v85, v13
    v_and_b32_dpp v30, v85, v14 row_ror:8 row_mask:0xf bank_mask:0xf
    v_and_b32_dpp v31, v85, v15 row_ror:8 row_mask:0xf bank_mask:0xf
    s_waitcnt vmcnt(5)
    s_nop 0
    v_mfma_f32_16x16x32_bf16 v[24:27], v[144:147], v[28:31], v[24:27]
    v_and_b32_dpp v32, v85, v12 row_ror:8 row_mask:0xf bank_mask:0xf
    v_and_b32_dpp v33, v85, v13 row_ror:8 row_mask:0xf bank_mask:0xf
    v_and_b32 v34, v85, v14
    v_and_b32 v35, v85, v15
    s_waitcnt vmcnt(4)
    s_nop 0
    v_mfma_f32_16x16x32_bf16 v[24:27], v[148:151], v[32:35], v[24:27]
    v_and_b32 v28, v86, v12
    v_and_b32 v29, v86, v13
    v_and_b32_dpp v30, v86, v14 row_ror:8 row_mask:0xf bank_mask:0xf
    v_and_b32_dpp v31, v86, v15 row_ror:8 row_mask:0xf bank_mask:0xf
    s_waitcnt vmcnt(3)
    s_nop 0
    v_mfma_f32_16x16x32_bf16 v[24:27], v[152:155], v[28:31], v[24:27]
    v_and_b32_dpp v32, v86, v12 row_ror:8 row_mask:0xf bank_mask:0xf
    v_and_b32_dpp v33, v86, v13 row_ror:8 row_mask:0xf bank_mask:0xf
    v_and_b32 v34, v86, v14
    v_and_b32 v35, v86, v15
    s_waitcnt vmcnt(2)
    s_nop 0
    v_mfma_f32_16x16x32_bf16 v[24:27], v[156:159], v[32:35], v[24:27]
    v_and_b32 v28, v87, v12
    v_and_b32 v29, v87, v13
    v_and_b32_dpp v30, v87, v14 row_ror:8 row_mask:0xf bank_mask:0xf
    v_and_b32_dpp v31, v87, v15 row_ror:8 row_mask:0xf bank_mask:0xf
    s_waitcnt vmcnt(1)
    s_nop 0
    v_mfma_f32_16x16x32_bf16 v[24:27], v[164:167], v[28:31], v[24:27]
    v_and_b32_dpp v32, v87, v12 row_ror:8 row_mask:0xf bank_mask:0xf
    v_and_b32_dpp v33, v87, v13 row_ror:8 row_mask:0xf bank_mask:0xf
    v_and_b32 v34, v87, v14
    v_and_b32 v35, v87, v15
    s_waitcnt vmcnt(0)
    s_nop 0
    v_mfma_f32_16x16x32_bf16 v[24:27], v[168:171], v[32:35], v[24:27]
    s_nop 7
    v_pk_mul_f32 v[24:25], v[24:25], v[6:7]
    v_pk_mul_f32 v[26:27], v[26:27], v[6:7]
    ds_write2_b32 v9, v24, v25 offset0:0 offset1:8
    ds_write2_b32 v9, v26, v27 offset0:16 offset1:24
    s_waitcnt lgkmcnt(0)
    s_barrier
    s_mov_b32 exec_hi, 0
    ds_read_b64 v[16:17], v10 offset:2048
    ds_read_b64 v[18:19], v10 offset:3584
    ds_read_b64 v[20:21], v10 offset:5120
    ds_read_b64 v[22:23], v10 offset:6656
    s_waitcnt lgkmcnt(2)
    v_pk_add_f32 v[16:17], v[16:17], v[18:19]
    s_waitcnt lgkmcnt(0)
    v_pk_add_f32 v[20:21], v[20:21], v[22:23]
    v_pk_add_f32 v[16:17], v[16:17], v[20:21]
    v_cvt_pk_bf16_f32 v3, v16, v17
    v_min_u32 v3, -2, v3
    buffer_store_dword v3, v11, s[52:55], s26 offen sc1
    s_barrier
    s_endpgm
L_amain:
    v_mov_b32 v6, 0
    v_mov_b32 v7, 1
    s_waitcnt vmcnt(5)
    s_mov_b64 exec, 1
    ds_add_u32 v6, v7 offset:12
    s_mov_b64 exec, -1
    s_mul_i32 s4, s10, 3072
    v_add_u32 v5, s4, v1
    s_mov_b32 s11, 400000
L_xw:
    ds_read_b32 v4, v6 offset:36
    ds_read_b128 v[8:11], v5 offset:17408
    ds_read_b128 v[12:15], v5 offset:18432
    ds_read_b128 v[16:19], v5 offset:19456
    s_waitcnt lgkmcnt(0)
    v_cmp_le_u32 vcc, 4, v4
    s_nop 0
    s_cmp_eq_u64 vcc, exec
    s_cbranch_scc1 L_xw_ok
    s_sub_u32 s11, s11, 1
    s_cmp_lg_u32 s11, 0
    s_cbranch_scc1 L_xw
L_xw_ok:
    v_perm_b32 v244, v120, v116, s12
    v_perm_b32 v245, v128, v124, s12
    v_perm_b32 v246, v136, v132, s12
    v_perm_b32 v247, v144, v140, s12
    v_perm_b32 v248, v120, v116, s13
    v_perm_b32 v249, v128, v124, s13
    v_perm_b32 v250, v136, v132, s13
    v_perm_b32 v251, v144, v140, s13
    v_mfma_f32_16x16x32_bf16 v[44:47], v[8:11], v[244:247], 0
    v_perm_b32 v244, v121, v117, s12
    v_perm_b32 v245, v129, v125, s12
    v_perm_b32 v246, v137, v133, s12
    v_perm_b32 v247, v145, v141, s12
    v_mfma_f32_16x16x32_bf16 v[48:51], v[8:11], v[248:251], 0
    v_perm_b32 v248, v121, v117, s13
    v_perm_b32 v249, v129, v125, s13
    v_perm_b32 v250, v137, v133, s13
    v_perm_b32 v251, v145, v141, s13
    v_mfma_f32_16x16x32_bf16 v[52:55], v[8:11], v[244:247], 0
    v_perm_b32 v244, v122, v118, s12
    v_perm_b32 v245, v130, v126, s12
    v_perm_b32 v246, v138, v134, s12
    v_perm_b32 v247, v146, v142, s12
    v_mfma_f32_16x16x32_bf16 v[56:59], v[8:11], v[248:251], 0
    v_perm_b32 v248, v122, v118, s13
    v_perm_b32 v249, v130, v126, s13
    v_perm_b32 v250, v138, v134, s13
    v_perm_b32 v251, v146, v142, s13
    v_mfma_f32_16x16x32_bf16 v[60:63], v[8:11], v[244:247], 0
    v_perm_b32 v244, v123, v119, s12
    v_perm_b32 v245, v131, v127, s12
    v_perm_b32 v246, v139, v135, s12
    v_perm_b32 v247, v147, v143, s12
    v_mfma_f32_16x16x32_bf16 v[64:67], v[8:11], v[248:251], 0
    v_perm_b32 v248, v123, v119, s13
    v_perm_b32 v249, v131, v127, s13
    v_perm_b32 v250, v139, v135, s13
    v_perm_b32 v251, v147, v143, s13
    v_mfma_f32_16x16x32_bf16 v[68:71], v[8:11], v[244:247], 0
    s_nop 0
    v_mfma_f32_16x16x32_bf16 v[72:75], v[8:11], v[248:251], 0
    v_perm_b32 v244, v152, v148, s12
    v_perm_b32 v245, v160, v156, s12
    v_perm_b32 v246, v168, v164, s12
    v_perm_b32 v247, v176, v172, s12
    v_perm_b32 v248, v152, v148, s13
    v_perm_b32 v249, v160, v156, s13
    v_perm_b32 v250, v168, v164, s13
    v_perm_b32 v251, v176, v172, s13
    v_mfma_f32_16x16x32_bf16 v[44:47], v[12:15], v[244:247], v[44:47]
    v_perm_b32 v244, v153, v149, s12
    v_perm_b32 v245, v161, v157, s12
    v_perm_b32 v246, v169, v165, s12
    v_perm_b32 v247, v177, v173, s12
    v_mfma_f32_16x16x32_bf16 v[48:51], v[12:15], v[248:251], v[48:51]
    v_perm_b32 v248, v153, v149, s13
    v_perm_b32 v249, v161, v157, s13
    v_perm_b32 v250, v169, v165, s13
    v_perm_b32 v251, v177, v173, s13
    v_mfma_f32_16x16x32_bf16 v[52:55], v[12:15], v[244:247], v[52:55]
    v_perm_b32 v244, v154, v150, s12
    v_perm_b32 v245, v162, v158, s12
    v_perm_b32 v246, v170, v166, s12
    v_perm_b32 v247, v178, v174, s12
    v_mfma_f32_16x16x32_bf16 v[56:59], v[12:15], v[248:251], v[56:59]
    v_perm_b32 v248, v154, v150, s13
    v_perm_b32 v249, v162, v158, s13
    v_perm_b32 v250, v170, v166, s13
    v_perm_b32 v251, v178, v174, s13
    v_mfma_f32_16x16x32_bf16 v[60:63], v[12:15], v[244:247], v[60:63]
    v_perm_b32 v244, v155, v151, s12
    v_perm_b32 v245, v163, v159, s12
    v_perm_b32 v246, v171, v167, s12
    v_perm_b32 v247, v179, v175, s12
    v_mfma_f32_16x16x32_bf16 v[64:67], v[12:15], v[248:251], v[64:67]
    v_perm_b32 v248, v155, v151, s13
    v_perm_b32 v249, v163, v159, s13
    v_perm_b32 v250, v171, v167, s13
    v_perm_b32 v251, v179, v175, s13
    v_mfma_f32_16x16x32_bf16 v[68:71], v[12:15], v[244:247], v[68:71]
    s_nop 0
    v_mfma_f32_16x16x32_bf16 v[72:75], v[12:15], v[248:251], v[72:75]
    s_waitcnt vmcnt(0)
    v_perm_b32 v244, v184, v180, s12
    v_perm_b32 v245, v192, v188, s12
    v_perm_b32 v246, v200, v196, s12
    v_perm_b32 v247, v208, v204, s12
    v_perm_b32 v248, v184, v180, s13
    v_perm_b32 v249, v192, v188, s13
    v_perm_b32 v250, v200, v196, s13
    v_perm_b32 v251, v208, v204, s13
    v_mfma_f32_16x16x32_bf16 v[44:47], v[16:19], v[244:247], v[44:47]
    v_perm_b32 v244, v185, v181, s12
    v_perm_b32 v245, v193, v189, s12
    v_perm_b32 v246, v201, v197, s12
    v_perm_b32 v247, v209, v205, s12
    v_mfma_f32_16x16x32_bf16 v[48:51], v[16:19], v[248:251], v[48:51]
    v_perm_b32 v248, v185, v181, s13
    v_perm_b32 v249, v193, v189, s13
    v_perm_b32 v250, v201, v197, s13
    v_perm_b32 v251, v209, v205, s13
    v_mfma_f32_16x16x32_bf16 v[52:55], v[16:19], v[244:247], v[52:55]
    v_perm_b32 v244, v186, v182, s12
    v_perm_b32 v245, v194, v190, s12
    v_perm_b32 v246, v202, v198, s12
    v_perm_b32 v247, v210, v206, s12
    v_mfma_f32_16x16x32_bf16 v[56:59], v[16:19], v[248:251], v[56:59]
    v_perm_b32 v248, v186, v182, s13
    v_perm_b32 v249, v194, v190, s13
    v_perm_b32 v250, v202, v198, s13
    v_perm_b32 v251, v210, v206, s13
    v_mfma_f32_16x16x32_bf16 v[60:63], v[16:19], v[244:247], v[60:63]
    v_perm_b32 v244, v187, v183, s12
    v_perm_b32 v245, v195, v191, s12
    v_perm_b32 v246, v203, v199, s12
    v_perm_b32 v247, v211, v207, s12
    v_mfma_f32_16x16x32_bf16 v[64:67], v[16:19], v[248:251], v[64:67]
    v_perm_b32 v248, v187, v183, s13
    v_perm_b32 v249, v195, v191, s13
    v_perm_b32 v250, v203, v199, s13
    v_perm_b32 v251, v211, v207, s13
    v_mfma_f32_16x16x32_bf16 v[68:71], v[16:19], v[244:247], v[68:71]
    s_nop 0
    v_mfma_f32_16x16x32_bf16 v[72:75], v[16:19], v[248:251], v[72:75]
    v_add_f32_dpp v244, v45, v44 row_ror:8 row_mask:0xf bank_mask:0x3
    v_add_f32_dpp v245, v49, v48 row_ror:8 row_mask:0xf bank_mask:0x3
    v_add_f32_dpp v246, v53, v52 row_ror:8 row_mask:0xf bank_mask:0x3
    v_add_f32_dpp v247, v57, v56 row_ror:8 row_mask:0xf bank_mask:0x3
    v_add_f32_dpp v248, v61, v60 row_ror:8 row_mask:0xf bank_mask:0x3
    v_add_f32_dpp v249, v65, v64 row_ror:8 row_mask:0xf bank_mask:0x3
    v_add_f32_dpp v250, v69, v68 row_ror:8 row_mask:0xf bank_mask:0x3
    s_nop 0
    v_add_f32_dpp v251, v73, v72 row_ror:8 row_mask:0xf bank_mask:0x3
    v_add_f32_dpp v244, v46, v47 row_ror:8 row_mask:0xf bank_mask:0xc
    v_add_f32_dpp v245, v50, v51 row_ror:8 row_mask:0xf bank_mask:0xc
    v_add_f32_dpp v246, v54, v55 row_ror:8 row_mask:0xf bank_mask:0xc
    v_add_f32_dpp v247, v58, v59 row_ror:8 row_mask:0xf bank_mask:0xc
    v_add_f32_dpp v248, v62, v63 row_ror:8 row_mask:0xf bank_mask:0xc
    v_add_f32_dpp v249, v66, v67 row_ror:8 row_mask:0xf bank_mask:0xc
    v_add_f32_dpp v250, v70, v71 row_ror:8 row_mask:0xf bank_mask:0xc
    v_add_f32_dpp v251, v74, v75 row_ror:8 row_mask:0xf bank_mask:0xc
    s_cmp_eq_u32 s3, 4
    s_cbranch_scc1 L_l1sum
    s_lshl_b32 s4, s10, 11
    v_add_u32 v5, s4, v1
    ds_write_b128 v5, v[244:247] offset:8192
    ds_write_b128 v5, v[248:251] offset:9216
    s_mov_b64 exec, 1
    s_waitcnt lgkmcnt(0)
    ds_add_u32 v6, v7 offset:32
    s_mov_b64 exec, -1
    s_branch L_h67
L_l1sum:
    s_mov_b32 s11, 400000
L_l1w:
    ds_read_b32 v8, v6 offset:32
    ds_read_b128 v[16:19], v1 offset:10240
    ds_read_b128 v[20:23], v1 offset:11264
    ds_read_b128 v[24:27], v1 offset:12288
    ds_read_b128 v[28:31], v1 offset:13312
    s_waitcnt lgkmcnt(0)
    v_cmp_le_u32 vcc, 2, v8
    s_nop 0
    s_cmp_eq_u64 vcc, exec
    s_cbranch_scc1 L_l1w_ok
    s_sub_u32 s11, s11, 1
    s_cmp_lg_u32 s11, 0
    s_cbranch_scc1 L_l1w
L_l1w_ok:
    v_pk_add_f32 v[244:245], v[244:245], v[16:17]
    v_pk_add_f32 v[246:247], v[246:247], v[18:19]
    v_pk_add_f32 v[248:249], v[248:249], v[20:21]
    v_pk_add_f32 v[250:251], v[250:251], v[22:23]
    v_pk_add_f32 v[244:245], v[244:245], v[24:25]
    v_pk_add_f32 v[246:247], v[246:247], v[26:27]
    v_pk_add_f32 v[248:249], v[248:249], v[28:29]
    v_pk_add_f32 v[250:251], v[250:251], v[30:31]
    v_cvt_pk_bf16_f32 v12, v244, v245
    v_cvt_pk_bf16_f32 v13, v246, v247
    v_cvt_pk_bf16_f32 v14, v248, v249
    v_cvt_pk_bf16_f32 v15, v250, v251
    v_min_u32 v12, -2, v12
    v_min_u32 v13, -2, v13
    v_min_u32 v14, -2, v14
    v_min_u32 v15, -2, v15
    s_branch L_l1done
L_nol1:
    s_mov_b32 s52, s38
    s_mov_b32 s53, s39
    s_mov_b32 s54, 0x40000000
    s_mov_b32 s55, 0x20000
    s_barrier
    s_cmp_lg_u32 s3, 4
    s_cbranch_scc1 L_h67
L_l1done:
    s_and_b32 s9, s2, 7
    s_lshr_b32 s8, s2, 3
    s_cmp_lt_u32 s8, 16
    s_cbranch_scc1 L_role3
    s_sub_u32 s8, s8, 16
    s_cmp_eq_u32 s9, 0
    s_cselect_b32 s9, 8, s9
    s_cbranch_scc1 L_role3
    s_add_u32 s8, s8, 16
    s_cmp_lt_u32 s8, 28
    s_cbranch_scc1 L_role3
    s_mul_i32 s8, s8, 7
    s_add_u32 s8, s8, s9
    s_sub_u32 s8, s8, 181
    s_mov_b32 s9, 0
    s_cmp_lt_u32 s8, 28
    s_cbranch_scc1 L_role3
    s_mov_b32 s9, 8
    s_sub_u32 s8, s8, 12
L_role3:
    v_mov_b32 v9, 0
    s_mov_b32 s11, 400000
L_amode:
    ds_read_b32 v8, v9 offset:0
    s_waitcnt lgkmcnt(0)
    v_cmp_ne_u32 vcc, 0, v8
    s_nop 0
    s_cmp_eq_u64 vcc, exec
    s_cbranch_scc1 L_amode_ok
    s_sub_u32 s11, s11, 1
    s_cmp_lg_u32 s11, 0
    s_cbranch_scc1 L_amode
L_amode_ok:
    v_readfirstlane_b32 s100, v8
    s_nop 0
    s_and_b32 s100, s100, 1
    s_and_b32 s72, s2, 7
    s_lshl_b32 s72, s72, 5
    s_lshr_b32 s4, s2, 3
    s_add_u32 s72, s72, s4
    s_lshl_b32 s72, s72, 10
    s_cmp_ge_u32 s2, 208
    s_cbranch_scc1 L_nol1st
    s_sub_u32 s4, s101, 8
    s_cmp_lt_u32 s4, 9
    s_cbranch_scc1 L_nol1st
    s_cmp_eq_u32 s100, 0
    s_cbranch_scc1 L_far4
    buffer_store_dwordx4 v[12:15], v1, s[52:55], s72 offen
    s_branch L_sent5
L_far4:
    buffer_store_dwordx4 v[12:15], v1, s[52:55], s72 offen sc1
L_sent5:
L_nol1st:
    v_bfe_u32 v3, v0, 2, 1
    v_lshlrev_b32 v3, 11, v3
    v_lshrrev_b32 v4, 5, v0
    v_lshl_or_b32 v3, v4, 10, v3
    v_bfe_u32 v4, v0, 4, 1
    v_lshl_or_b32 v3, v4, 6, v3
    v_and_b32 v4, 3, v0
    v_lshl_or_b32 v10, v4, 4, v3
    s_and_b32 s4, s2, 7
    s_lshl_b32 s4, s4, 15
    s_and_b32 s5, s6, 1
    s_lshl_b32 s5, s5, 12
    s_add_u32 s4, s4, s5
    s_lshr_b32 s5, s6, 4
    s_lshl_b32 s5, s5, 7
    s_add_u32 s4, s4, s5
    buffer_load_dwordx4 v[4:7], v10, s[52:55], s4 offen sc1
    s_waitcnt vmcnt(0)
    s_mov_b32 s11, 400000
    v_max3_u32 v3, v4, v5, v6
    v_max_u32 v3, v3, v7
    v_cmp_eq_u32 vcc, -1, v3
    s_nop 0
    s_and_b64 exec, exec, vcc
    s_cbranch_scc0 L_qpoll_ok
L_qpoll:
    buffer_load_dwordx4 v[4:7], v10, s[52:55], s4 offen sc1
    s_waitcnt vmcnt(0)
    v_max3_u32 v3, v4, v5, v6
    v_max_u32 v3, v3, v7
    v_cmp_eq_u32 vcc, -1, v3
    s_nop 0
    s_and_b64 exec, exec, vcc
    s_cbranch_scc0 L_qpoll_ok
    s_sub_u32 s11, s11, 1
    s_cmp_lg_u32 s11, 0
    s_cbranch_scc1 L_qpoll
L_qpoll_ok:
    s_mov_b64 exec, -1
    ds_write_b128 v1, v[4:7] offset:1024
    s_waitcnt lgkmcnt(0)
    ds_write_b32 v9, v8 offset:8
    s_waitcnt lgkmcnt(0)
    s_sub_u32 s4, s101, 8
    s_cmp_ge_u32 s4, 9
    s_cbranch_scc1 L_noh
    s_add_u32 s4, s72, 9216
    buffer_load_dwordx4 v[16:19], v1, s[52:55], s4 offen sc1
    s_waitcnt vmcnt(0)
    s_mov_b32 s11, 400000
    v_max3_u32 v3, v16, v17, v18
    v_max_u32 v3, v3, v19
    v_cmp_eq_u32 vcc, -1, v3
    s_nop 0
    s_and_b64 exec, exec, vcc
    s_cbranch_scc0 L_upoll_ok
L_upoll:
    buffer_load_dwordx4 v[16:19], v1, s[52:55], s4 offen sc1
    s_waitcnt vmcnt(0)
    v_max3_u32 v3, v16, v17, v18
    v_max_u32 v3, v3, v19
    v_cmp_eq_u32 vcc, -1, v3
    s_nop 0
    s_and_b64 exec, exec, vcc
    s_cbranch_scc0 L_upoll_ok
    s_sub_u32 s11, s11, 1
    s_cmp_lg_u32 s11, 0
    s_cbranch_scc1 L_upoll
L_upoll_ok:
    s_mov_b64 exec, -1
    s_mov_b32 s4, 0x3d372713
    s_mov_b32 s5, 0xc0135761
    v_lshlrev_b32 v24, 16, v12
    v_and_b32 v25, 0xffff0000, v12
    v_lshlrev_b32 v26, 16, v13
    v_and_b32 v27, 0xffff0000, v13
    v_lshlrev_b32 v28, 16, v14
    v_and_b32 v29, 0xffff0000, v14
    v_lshlrev_b32 v30, 16, v15
    v_and_b32 v31, 0xffff0000, v15
    v_mul_f32 v32, v24, v24
    v_mul_f32 v33, v25, v25
    v_mul_f32 v34, v26, v26
    v_mul_f32 v35, v27, v27
    v_mul_f32 v36, v28, v28
    v_mul_f32 v37, v29, v29
    v_mul_f32 v38, v30, v30
    v_mul_f32 v39, v31, v31
    v_fma_f32 v32, v32, s4, 1.0
    v_fma_f32 v33, v33, s4, 1.0
    v_fma_f32 v34, v34, s4, 1.0
    v_fma_f32 v35, v35, s4, 1.0
    v_fma_f32 v36, v36, s4, 1.0
    v_fma_f32 v37, v37, s4, 1.0
    v_fma_f32 v38, v38, s4, 1.0
    v_fma_f32 v39, v39, s4, 1.0
    v_mul_f32 v32, v32, v24
    v_mul_f32 v33, v33, v25
    v_mul_f32 v34, v34, v26
    v_mul_f32 v35, v35, v27
    v_mul_f32 v36, v36, v28
    v_mul_f32 v37, v37, v29
    v_mul_f32 v38, v38, v30
    v_mul_f32 v39, v39, v31
    v_mul_f32 v32, s5, v32
    v_mul_f32 v33, s5, v33
    v_mul_f32 v34, s5, v34
    v_mul_f32 v35, s5, v35
    v_mul_f32 v36, s5, v36
    v_mul_f32 v37, s5, v37
    v_mul_f32 v38, s5, v38
    v_mul_f32 v39, s5, v39
    v_exp_f32 v32, v32
    v_exp_f32 v33, v33
    v_exp_f32 v34, v34
    v_exp_f32 v35, v35
    v_exp_f32 v36, v36
    v_exp_f32 v37, v37
    v_exp_f32 v38, v38
    v_exp_f32 v39, v39
    v_add_f32 v32, 1.0, v32
    v_add_f32 v33, 1.0, v33
    v_add_f32 v34, 1.0, v34
    v_add_f32 v35, 1.0, v35
    v_add_f32 v36, 1.0, v36
    v_add_f32 v37, 1.0, v37
    v_add_f32 v38, 1.0, v38
    v_add_f32 v39, 1.0, v39
    v_rcp_f32 v32, v32
    v_rcp_f32 v33, v33
    v_rcp_f32 v34, v34
    v_rcp_f32 v35, v35
    v_rcp_f32 v36, v36
    v_rcp_f32 v37, v37
    v_rcp_f32 v38, v38
    v_rcp_f32 v39, v39
    v_mul_f32 v24, v24, v32
    v_mul_f32 v25, v25, v33
    v_mul_f32 v26, v26, v34
    v_mul_f32 v27, v27, v35
    v_mul_f32 v28, v28, v36
    v_mul_f32 v29, v29, v37
    v_mul_f32 v30, v30, v38
    v_mul_f32 v31, v31, v39
    v_cvt_pk_bf16_f32 v12, v24, v25
    v_cvt_pk_bf16_f32 v13, v26, v27
    v_cvt_pk_bf16_f32 v14, v28, v29
    v_cvt_pk_bf16_f32 v15, v30, v31
    v_lshlrev_b32 v24, 16, v12
    v_and_b32 v25, 0xffff0000, v12
    v_lshlrev_b32 v26, 16, v13
    v_and_b32 v27, 0xffff0000, v13
    v_lshlrev_b32 v28, 16, v14
    v_and_b32 v29, 0xffff0000, v14
    v_lshlrev_b32 v30, 16, v15
    v_and_b32 v31, 0xffff0000, v15
    v_lshlrev_b32 v32, 16, v16
    v_and_b32 v33, 0xffff0000, v16
    v_lshlrev_b32 v34, 16, v17
    v_and_b32 v35, 0xffff0000, v17
    v_lshlrev_b32 v36, 16, v18
    v_and_b32 v37, 0xffff0000, v18
    v_lshlrev_b32 v38, 16, v19
    v_and_b32 v39, 0xffff0000, v19
    v_mul_f32 v24, v24, v32
    v_mul_f32 v25, v25, v33
    v_mul_f32 v26, v26, v34
    v_mul_f32 v27, v27, v35
    v_mul_f32 v28, v28, v36
    v_mul_f32 v29, v29, v37
    v_mul_f32 v30, v30, v38
    v_mul_f32 v31, v31, v39
    v_cvt_pk_bf16_f32 v12, v24, v25
    v_cvt_pk_bf16_f32 v13, v26, v27
    v_cvt_pk_bf16_f32 v14, v28, v29
    v_cvt_pk_bf16_f32 v15, v30, v31
    v_min_u32 v12, -2, v12
    v_min_u32 v13, -2, v13
    v_min_u32 v14, -2, v14
    v_min_u32 v15, -2, v15
    s_lshl_b32 s4, s74, 10
    s_add_u32 s4, s4, 294912
    v_bfe_u32 v3, v0, 1, 2
    v_lshlrev_b32 v3, 8, v3
    v_lshrrev_b32 v4, 3, v0
    v_lshl_or_b32 v3, v4, 5, v3
    v_and_b32 v4, 1, v0
    v_lshl_or_b32 v3, v4, 4, v3
    buffer_store_dwordx4 v[12:15], v3, s[52:55], s4 offen sc1
L_noh:
    s_cmp_lt_u32 s8, 28
    s_cbranch_scc1 L_l2
    s_branch L_hdone
L_h5:
    s_and_b32 s9, s2, 7
    s_lshr_b32 s8, s2, 3
    s_cmp_lt_u32 s8, 16
    s_cbranch_scc1 L_role6
    s_sub_u32 s8, s8, 16
    s_cmp_eq_u32 s9, 0
    s_cselect_b32 s9, 8, s9
    s_cbranch_scc1 L_role6
    s_add_u32 s8, s8, 16
    s_cmp_lt_u32 s8, 28
    s_cbranch_scc1 L_role6
    s_mul_i32 s8, s8, 7
    s_add_u32 s8, s8, s9
    s_sub_u32 s8, s8, 181
    s_mov_b32 s9, 0
    s_cmp_lt_u32 s8, 28
    s_cbranch_scc1 L_role6
    s_mov_b32 s9, 8
    s_sub_u32 s8, s8, 12
L_role6:
    v_mov_b32 v4, 0
    v_mov_b32 v5, 0
    v_mov_b32 v6, 0
    v_mov_b32 v7, 0
    ds_write_b128 v4, v[4:7] offset:0
    ds_write_b128 v4, v[4:7] offset:32
    ds_write_b128 v4, v[4:7] offset:16384
    s_waitcnt lgkmcnt(0)
    s_mov_b32 s52, s38
    s_mov_b32 s53, s39
    s_mov_b32 s54, 0x40000000
    s_mov_b32 s55, 0x20000
    v_mov_b32 v4, -1
    v_mov_b32 v5, -1
    v_mov_b32 v6, -1
    v_mov_b32 v7, -1
    s_and_b32 s4, s6, 15
    s_lshl_b32 s4, s4, 13
    s_lshr_b32 s5, s6, 4
    s_lshl_b32 s5, s5, 1
    s_add_u32 s5, s5, s7
    s_lshl_b32 s5, s5, 6
    s_add_u32 s4, s4, s5
    s_add_u32 s74, s4, 1048576
    v_lshlrev_b32 v3, 3, v0
    s_mul_i32 s4, s7, 960
    s_add_u32 s74, s74, s4
    v_and_b32 v3, 15, v0
    v_lshlrev_b32 v3, 3, v3
    v_lshrrev_b32 v8, 4, v0
    v_lshl_or_b32 v3, v8, 11, v3
    buffer_store_dwordx2 v[4:5], v3, s[52:55], s74 offen sc1
    s_lshr_b32 s4, s2, 3
    s_sub_u32 s4, s4, 8
    s_cmp_ge_u32 s4, 9
    s_cbranch_scc1 L_nohcl
    s_and_b32 s5, s2, 7
    s_mul_i32 s5, s5, 9
    s_add_u32 s4, s4, s5
    s_lshl_b32 s4, s4, 10
    s_add_u32 s4, s4, 294912
    buffer_store_dwordx4 v[4:7], v1, s[52:55], s4 offen sc1
L_nohcl:
    s_and_b32 s5, s2, 7
    s_lshl_b32 s5, s5, 5
    s_lshr_b32 s4, s2, 3
    s_add_u32 s5, s5, s4
    s_lshl_b32 s5, s5, 10
    s_lshr_b32 s4, s2, 3
    s_lshl_b32 s4, 1, s4
    s_and_b32 s4, s4, 0x3fe00ff
    s_cbranch_scc0 L_nol7
    buffer_load_dword v10, v1, s[52:55], s5 offen
L_nol7:
    s_lshl_b32 s4, s6, 1
    s_add_u32 s4, s4, s7
    s_lshl_b32 s4, s4, 7
    s_add_u32 s4, s4, 262144
    s_mov_b64 exec, 0xff
    buffer_load_dword v10, v1, s[52:55], s4 offen
    s_mov_b64 exec, -1
    s_cmp_ge_u32 s8, 28
    s_cbranch_scc1 L_nop8
    v_lshrrev_b32 v8, 3, v0
    v_mul_u32_u24 v8, 3584, v8
    v_and_b32 v9, 7, v0
    v_lshl_add_u32 v8, v9, 4, v8
    s_mul_i32 s4, s9, 28672
    s_lshl_b32 s5, s8, 7
    s_add_u32 s4, s4, s5
    s_add_u32 s4, s4, 524288
    s_add_u32 s5, s4, 14336
    s_cmp_lt_u32 s2, 224
    s_cselect_b32 s10, 0, s8
    s_cmp_ge_u32 s10, 16
    s_cbranch_scc1 L_nop8
    buffer_load_dword v10, v8, s[52:55], s4 offen
L_nop8:
    s_and_b32 s74, s2, 7
    s_lshl_b32 s74, s74, 8
    s_add_u32 s74, s74, 393216
    s_lshr_b32 s72, s2, 3
    s_lshl_b32 s72, s72, 2
    s_add_u32 s72, s72, s74
    s_mov_b64 exec, 1
    buffer_load_dword v10, v1, s[52:55], s74 offen
    s_mov_b64 exec, -1
    s_barrier
    s_waitcnt vmcnt(0)
    s_and_b32 s5, s2, 7
    s_lshl_b32 s5, s5, 5
    s_lshr_b32 s4, s2, 3
    s_add_u32 s5, s5, s4
    s_lshl_b32 s5, s5, 10
    s_lshr_b32 s4, s2, 3
    s_lshl_b32 s4, 1, s4
    s_and_b32 s4, s4, 0x3fe00ff
    s_cbranch_scc0 L_nol10
    buffer_store_dwordx4 v[4:7], v1, s[52:55], s5 offen
L_nol10:
    s_lshl_b32 s4, s6, 1
    s_add_u32 s4, s4, s7
    s_lshl_b32 s4, s4, 7
    s_add_u32 s4, s4, 262144
    s_mov_b64 exec, 0xff
    buffer_store_dwordx4 v[4:7], v1, s[52:55], s4 offen
    s_mov_b64 exec, -1
    s_cmp_ge_u32 s8, 28
    s_cbranch_scc1 L_nop11
    v_lshrrev_b32 v8, 3, v0
    v_mul_u32_u24 v8, 3584, v8
    v_and_b32 v9, 7, v0
    v_lshl_add_u32 v8, v9, 4, v8
    s_mul_i32 s4, s9, 28672
    s_lshl_b32 s5, s8, 7
    s_add_u32 s4, s4, s5
    s_add_u32 s4, s4, 524288
    s_add_u32 s5, s4, 14336
    s_cmp_lt_u32 s2, 224
    s_cselect_b32 s10, 0, s8
    s_cmp_ge_u32 s10, 16
    s_cbranch_scc1 L_rem12
    buffer_store_dwordx4 v[4:7], v8, s[52:55], s4 offen
    s_branch L_nop11
L_rem12:
    buffer_store_dwordx4 v[4:7], v8, s[52:55], s4 offen sc1
L_nop11:
    v_mov_b32 v11, 76
    s_mov_b64 exec, 1
    buffer_store_dword v11, v1, s[52:55], s72 offen
    s_mov_b64 exec, -1
    s_getreg_b32 s5, hwreg(HW_REG_XCC_ID, 0, 3)
    s_or_b32 s5, s5, 8
    s_and_b32 s4, s2, 7
    s_lshl_b32 s4, s4, 2
    s_lshl_b32 s5, s5, s4
    s_bfe_u32 s4, s2, 0x30003
    s_lshl_b32 s4, s4, 2
    s_and_b32 s10, s2, 192
    s_add_u32 s4, s4, s10
    s_waitcnt vmcnt(0)
    s_atomic_or s5, s[36:37], s4
    s_waitcnt lgkmcnt(0)
L_h67:
    s_and_b32 s9, s2, 7
    s_lshr_b32 s8, s2, 3
    s_cmp_lt_u32 s8, 16
    s_cbranch_scc1 L_role13
    s_sub_u32 s8, s8, 16
    s_cmp_eq_u32 s9, 0
    s_cselect_b32 s9, 8, s9
    s_cbranch_scc1 L_role13
    s_add_u32 s8, s8, 16
    s_cmp_lt_u32 s8, 28
    s_cbranch_scc1 L_role13
    s_mul_i32 s8, s8, 7
    s_add_u32 s8, s8, s9
    s_sub_u32 s8, s8, 181
    s_mov_b32 s9, 0
    s_cmp_lt_u32 s8, 28
    s_cbranch_scc1 L_role13
    s_mov_b32 s9, 8
    s_sub_u32 s8, s8, 12
L_role13:
    s_cmp_eq_u32 s3, 7
    s_cselect_b32 s4, 0, s8
    s_cmp_ge_u32 s4, 28
    s_cbranch_scc1 L_hdone
    s_cmp_lg_u32 s3, 7
    s_cbranch_scc1 L_l2
    v_mov_b32 v9, 0
    s_cmp_ge_u32 s2, 208
    s_cselect_b32 s26, 34, 16
    s_mov_b32 s64, s36
    s_mov_b32 s65, s37
    s_mov_b32 s66, 256
    s_mov_b32 s67, 0x20000
    v_and_b32 v253, 7, v0
    v_and_b32 v254, 24, v0
    v_lshl_or_b32 v253, v254, 1, v253
    v_lshlrev_b32 v253, 2, v253
    s_mov_b32 s5, 0x88888888
L_fl:
    s_mov_b32 s11, 400000
L_mwait:
    ds_read_b128 v[12:15], v9 offset:16384
    s_waitcnt lgkmcnt(0)
    v_min3_u32 v5, v12, v13, v14
    v_min_u32 v5, v5, v15
    v_cmp_le_u32 vcc, s26, v5
    s_nop 0
    s_cmp_eq_u64 vcc, exec
    s_cbranch_scc1 L_mwait_ok
    s_sub_u32 s11, s11, 1
    s_cmp_lg_u32 s11, 0
    s_cbranch_scc1 L_mwait
L_mwait_ok:
    buffer_load_dword v252, v253, s[64:67], 0 offen sc1
    s_waitcnt vmcnt(0)
    v_and_b32 v8, s5, v252
    v_cmp_eq_u32 vcc, s5, v8
    s_nop 0
    s_cmp_eq_u64 vcc, exec
    s_cbranch_scc1 L_flags_ok
    v_readfirstlane_b32 s26, v5
    s_nop 0
    s_add_u32 s26, s26, 10
    s_cmp_le_u32 s26, 50
    s_cbranch_scc1 L_fl
    s_mov_b32 s5, 0x88888888
    v_and_b32 v8, s5, v252
    v_cmp_eq_u32 vcc, s5, v8
    s_nop 0
    s_cmp_eq_u64 vcc, exec
    s_cbranch_scc1 L_flags_ok
    s_mov_b32 s11, 400000
L_flags:
    buffer_load_dword v252, v253, s[64:67], 0 offen sc1
    s_waitcnt vmcnt(0)
    v_and_b32 v8, s5, v252
    v_cmp_eq_u32 vcc, s5, v8
    s_nop 0
    s_cmp_eq_u64 vcc, exec
    s_cbranch_scc1 L_flags_ok
    s_sub_u32 s11, s11, 1
    s_cmp_lg_u32 s11, 0
    s_cbranch_scc1 L_flags
L_flags_ok:
    v_readfirstlane_b32 s4, v252
    s_nop 1
    v_cmp_eq_u32 vcc, s4, v252
    s_nop 0
    s_cmp_eq_u64 vcc, exec
    s_cselect_b32 s100, 1, 0
    s_cmp_lg_u32 s100, 0
    s_cbranch_scc1 L_mode_ok
    v_mov_b32 v16, -1
    v_mov_b32 v17, -1
    v_mov_b32 v18, -1
    v_mov_b32 v19, -1
    s_and_b32 s5, s2, 7
    s_lshl_b32 s5, s5, 5
    s_lshr_b32 s4, s2, 3
    s_add_u32 s5, s5, s4
    s_lshl_b32 s5, s5, 10
    s_lshr_b32 s4, s2, 3
    s_lshl_b32 s4, 1, s4
    s_and_b32 s4, s4, 0x3fe00ff
    s_cbranch_scc0 L_nol14
    buffer_store_dwordx4 v[16:19], v1, s[52:55], s5 offen sc1
L_nol14:
    s_lshl_b32 s4, s6, 1
    s_add_u32 s4, s4, s7
    s_lshl_b32 s4, s4, 7
    s_add_u32 s4, s4, 262144
    s_mov_b64 exec, 0xff
    buffer_store_dwordx4 v[16:19], v1, s[52:55], s4 offen sc1
    s_mov_b64 exec, -1
    s_cmp_ge_u32 s8, 28
    s_cbranch_scc1 L_nop15
    v_lshrrev_b32 v20, 3, v0
    v_mul_u32_u24 v20, 3584, v20
    v_and_b32 v21, 7, v0
    v_lshl_add_u32 v20, v21, 4, v20
    s_mul_i32 s4, s9, 28672
    s_lshl_b32 s5, s8, 7
    s_add_u32 s4, s4, s5
    s_add_u32 s4, s4, 524288
    s_add_u32 s5, s4, 14336
    buffer_store_dwordx4 v[16:19], v20, s[52:55], s4 offen sc1
L_nop15:
    s_lshl_b32 s10, s2, 7
    s_add_u32 s10, s10, 425984
    v_lshlrev_b32 v20, 7, v0
    v_mov_b32 v21, 1
    s_mov_b64 exec, 1
    buffer_store_dword v16, v20, s[52:55], s10 offen sc1
    s_waitcnt vmcnt(0)
    s_and_b32 s5, s2, 3
    s_lshl_b32 s5, s5, 6
    s_add_u32 s5, s5, 36
    s_mov_b32 s4, 1
    s_atomic_add s4, s[36:37], s5 glc
    s_waitcnt lgkmcnt(0)
    s_and_b32 s4, s4, 63
    s_cmp_lg_u32 s4, 63
    s_cbranch_scc1 L_notlast
    s_mov_b32 s4, 1
    s_atomic_add s4, s[36:37], 40 glc
    s_waitcnt lgkmcnt(0)
    s_and_b32 s4, s4, 3
    s_cmp_lg_u32 s4, 3
    s_cbranch_scc1 L_notlast
    s_mov_b64 exec, -1
    s_mov_b32 s4, 425984
    buffer_store_dword v21, v20, s[52:55], s4 offen sc1
    s_mov_b32 s4, 434176
    buffer_store_dword v21, v20, s[52:55], s4 offen sc1
    s_mov_b32 s4, 442368
    buffer_store_dword v21, v20, s[52:55], s4 offen sc1
    s_mov_b32 s4, 450560
    buffer_store_dword v21, v20, s[52:55], s4 offen sc1
    s_mov_b64 exec, 1
L_notlast:
    s_mov_b32 s11, 400000
L_far:
    buffer_load_dword v8, v20, s[52:55], s10 offen sc1
    s_waitcnt vmcnt(0)
    v_cmp_ne_u32 vcc, -1, v8
    s_nop 0
    s_cmp_eq_u64 vcc, exec
    s_cbranch_scc1 L_far_ok
    s_sub_u32 s11, s11, 1
    s_cmp_lg_u32 s11, 0
    s_cbranch_scc1 L_far
L_far_ok:
    s_mov_b64 exec, -1
L_mode_ok:
    s_add_u32 s4, s100, 2
    v_mov_b32 v8, s4
    v_mov_b32 v9, 0
    ds_write_b32 v9, v8 offset:0
    s_cmp_eq_u32 s100, 0
    s_cbranch_scc1 L_ctl_done
    s_and_b32 s74, s2, 7
    s_lshl_b32 s74, s74, 8
    s_add_u32 s74, s74, 393216
    s_lshr_b32 s72, s2, 3
    s_lshl_b32 s72, s72, 2
    s_add_u32 s72, s72, s74
    v_and_b32 v8, 31, v0
    v_lshlrev_b32 v8, 2, v8
    s_and_b32 s4, s2, 7
    s_cselect_b32 s4, s2, 0
    s_cmp_ge_u32 s4, 224
    s_cselect_b32 s75, 128, 0
    s_mov_b32 s15, s75
    s_add_u32 s75, s75, 104
    s_getreg_b32 s4, hwreg(HW_REG_XCC_ID, 0, 1)
    s_mul_i32 s4, s4, -25
    s_add_u32 s4, s4, 12
    s_add_u32 s75, s75, s4
    s_mov_b32 s11, 400000
L_ctl:
    ds_read_b128 v[12:15], v9 offset:16384
    s_waitcnt lgkmcnt(0)
    v_add3_u32 v12, v12, v13, v14
    v_add_u32 v12, v12, v15
    s_mov_b64 exec, 1
    buffer_store_dword v12, v9, s[52:55], s72 offen
    s_mov_b64 exec, -1
    v_readfirstlane_b32 s14, v12
    s_nop 0
    s_cmp_ge_u32 s14, 464
    s_cbranch_scc1 L_ctl_end
    buffer_load_dword v16, v8, s[52:55], s74 offen sc1
    s_waitcnt vmcnt(0)
    v_add_u32_dpp v16, v16, v16 row_ror:8 row_mask:0xf bank_mask:0xf
    s_nop 1
    v_add_u32_dpp v16, v16, v16 row_ror:4 row_mask:0xf bank_mask:0xf
    s_nop 1
    v_add_u32_dpp v16, v16, v16 row_ror:2 row_mask:0xf bank_mask:0xf
    s_nop 1
    v_add_u32_dpp v16, v16, v16 row_ror:1 row_mask:0xf bank_mask:0xf
    v_mov_b32 v17, v16
    s_nop 1
    v_permlane16_swap_b32 v16, v17
    v_add_u32 v16, v16, v17
    v_lshrrev_b32 v16, 2, v16
    v_lshlrev_b32 v12, 3, v12
    v_sub_u32 v16, v16, v12
    v_add_u32 v16, s75, v16
    s_cmp_lt_u32 s14, 288
    s_cselect_b32 s4, s15, 0
    v_subrev_u32 v16, s4, v16
    s_mov_b64 exec, 1
    ds_write_b32 v9, v16 offset:4
    s_mov_b64 exec, -1
    s_sub_u32 s11, s11, 1
    s_cmp_lg_u32 s11, 0
    s_cbranch_scc1 L_ctl
L_ctl_end:
    v_mov_b32 v13, 508
    s_mov_b64 exec, 1
    buffer_store_dword v13, v9, s[52:55], s72 offen
    s_mov_b64 exec, -1
L_ctl_done:
    s_cmp_ge_u32 s8, 16
    s_cbranch_scc1 L_hdone
L_l2:
    s_sub_u32 s101, s3, 4
    s_mul_i32 s73, s9, 28672
    s_lshl_b32 s5, s8, 7
    s_add_u32 s73, s73, s5
    s_add_u32 s73, s73, 524288
    s_lshl_b32 s4, s101, 11
    v_add_u32 v5, s4, v1
    s_cmp_ge_u32 s8, 16
    s_cbranch_scc1 L_down
    s_mov_b32 s60, s24
    s_mov_b32 s61, s25
    s_mov_b32 s62, 4718592
    s_mov_b32 s63, 0x20000
    s_mov_b32 s48, s16
    s_mov_b32 s49, s17
    s_mov_b32 s50, 9216
    s_mov_b32 s51, 0x20000
    s_mov_b32 s68, s34
    s_mov_b32 s69, s35
    s_mov_b32 s70, 9216
    s_mov_b32 s71, 0x20000
    v_lshrrev_b32 v3, 4, v0
    v_and_b32 v4, 15, v0
    v_lshlrev_b32 v9, 6, v4
    v_lshl_or_b32 v9, v3, 4, v9
    v_bfe_u32 v8, v0, 3, 1
    v_and_b32 v4, 7, v0
    v_mul_u32_u24 v2, 9216, v3
    v_mul_u32_u24 v6, 36864, v8
    v_add_u32 v2, v2, v6
    v_lshl_add_u32 v2, v4, 4, v2
    v_mul_u32_u24 v7, 7168, v3
    v_lshl_add_u32 v7, v4, 4, v7
    v_lshl_add_u32 v7, v8, 3, v7
    s_lshl_b32 s72, s8, 2
    s_add_u32 s72, s72, s101
    s_mul_i32 s72, s72, 73728
    s_lshl_b32 s4, s9, 7
    s_add_u32 s72, s72, s4
    s_lshl_b32 s14, s8, 13
    s_lshl_b32 s5, s101, 11
    s_add_u32 s14, s14, s5
    s_add_u32 s14, s14, 1048576
    s_and_b32 s15, s101, 1
    s_mul_i32 s4, s15, 3584
    s_add_u32 s73, s73, s4
    s_lshl_b32 s4, s15, 10
    v_add_u32 v6, s4, v1
    s_lshr_b32 s4, s8, 1
    s_and_b32 s5, s8, 1
    s_lshl_b32 s5, s5, 1
    s_add_u32 s5, s5, s15
    s_lshl_b32 s74, s9, 3
    s_add_u32 s74, s74, s4
    s_mul_i32 s74, s74, 3584
    s_lshl_b32 s15, s5, 5
    s_add_u32 s74, s74, s15
    s_add_u32 s74, s74, 524288
    s_mul_i32 s75, s4, 1152
    s_lshl_b32 s15, s9, 7
    s_add_u32 s75, s75, s15
    s_lshl_b32 s15, s5, 5
    s_add_u32 s75, s75, s15
    s_add_u32 s15, s74, 2048
    s_add_u32 s10, s72, 4608
    v_and_b32 v4, 3, v0
    v_lshlrev_b32 v11, 3, v4
    v_lshl_or_b32 v11, v3, 1, v11
    v_lshrrev_b32 v3, 2, v0
    v_lshlrev_b32 v3, 7, v3
    v_lshl_or_b32 v10, v4, 3, v3
    buffer_load_ushort v116, v11, s[48:51], s75 offen
    v_mov_b32 v108, 0
    v_mov_b32 v109, 0
    v_mov_b32 v110, 0
    v_mov_b32 v111, 0
    s_barrier
    buffer_load_dwordx4 v[40:43], v2, s[60:63], s72 offen offset:0 nt
    buffer_load_dwordx4 v[44:47], v2, s[60:63], s72 offen offset:1152 nt
    buffer_load_dwordx4 v[48:51], v2, s[60:63], s72 offen offset:2304 nt
    v_mov_b32 v14, 0
    ds_read_b32 v14, v14 offset:0
    s_waitcnt lgkmcnt(0)
    v_readfirstlane_b32 s100, v14
    s_nop 0
    s_and_b32 s100, s100, 1
    s_barrier
    s_barrier
    buffer_load_dwordx4 v[52:55], v2, s[60:63], s72 offen offset:3456 nt
    buffer_load_dwordx4 v[56:59], v2, s[60:63], s10 offen offset:0 nt
    buffer_load_dwordx4 v[60:63], v2, s[60:63], s10 offen offset:1152 nt
    buffer_load_dwordx4 v[64:67], v2, s[60:63], s10 offen offset:2304 nt
    buffer_load_dwordx4 v[68:71], v2, s[60:63], s10 offen offset:3456 nt
    s_waitcnt vmcnt(7)
    s_waitcnt vmcnt(6)
    v_mov_b32 v120, v40
    v_mov_b32 v121, v41
    v_mov_b32 v122, v44
    v_mov_b32 v123, v45
    v_mov_b32_dpp v40, v42 row_ror:8 row_mask:0xf bank_mask:0xc
    v_mov_b32_dpp v41, v43 row_ror:8 row_mask:0xf bank_mask:0xc
    v_mov_b32_dpp v44, v46 row_ror:8 row_mask:0xf bank_mask:0xc
    v_mov_b32_dpp v45, v47 row_ror:8 row_mask:0xf bank_mask:0xc
    v_mov_b32_dpp v42, v120 row_ror:8 row_mask:0xf bank_mask:0x3
    v_mov_b32_dpp v43, v121 row_ror:8 row_mask:0xf bank_mask:0x3
    v_mov_b32_dpp v46, v122 row_ror:8 row_mask:0xf bank_mask:0x3
    v_mov_b32_dpp v47, v123 row_ror:8 row_mask:0xf bank_mask:0x3
    v_perm_b32 v72, v44, v40, s12
    v_perm_b32 v76, v44, v40, s13
    v_perm_b32 v80, v45, v41, s12
    v_perm_b32 v84, v45, v41, s13
    v_perm_b32 v88, v46, v42, s12
    v_perm_b32 v92, v46, v42, s13
    v_perm_b32 v96, v47, v43, s12
    v_perm_b32 v100, v47, v43, s13
    s_waitcnt vmcnt(5)
    s_waitcnt vmcnt(4)
    buffer_load_dwordx4 v[16:19], v9, s[52:55], s14 offen offset:0 sc1
    buffer_load_dwordx4 v[20:23], v9, s[52:55], s14 offen offset:1024 sc1
    v_mov_b32 v124, v48
    v_mov_b32 v125, v49
    v_mov_b32 v126, v52
    v_mov_b32 v127, v53
    v_mov_b32_dpp v48, v50 row_ror:8 row_mask:0xf bank_mask:0xc
    v_mov_b32_dpp v49, v51 row_ror:8 row_mask:0xf bank_mask:0xc
    v_mov_b32_dpp v52, v54 row_ror:8 row_mask:0xf bank_mask:0xc
    v_mov_b32_dpp v53, v55 row_ror:8 row_mask:0xf bank_mask:0xc
    v_mov_b32_dpp v50, v124 row_ror:8 row_mask:0xf bank_mask:0x3
    v_mov_b32_dpp v51, v125 row_ror:8 row_mask:0xf bank_mask:0x3
    v_mov_b32_dpp v54, v126 row_ror:8 row_mask:0xf bank_mask:0x3
    v_mov_b32_dpp v55, v127 row_ror:8 row_mask:0xf bank_mask:0x3
    v_perm_b32 v73, v52, v48, s12
    v_perm_b32 v77, v52, v48, s13
    v_perm_b32 v81, v53, v49, s12
    v_perm_b32 v85, v53, v49, s13
    v_perm_b32 v89, v54, v50, s12
    v_perm_b32 v93, v54, v50, s13
    v_perm_b32 v97, v55, v51, s12
    v_perm_b32 v101, v55, v51, s13
    s_waitcnt vmcnt(5)
    s_waitcnt vmcnt(4)
    v_mov_b32 v128, v56
    v_mov_b32 v129, v57
    v_mov_b32 v130, v60
    v_mov_b32 v131, v61
    v_mov_b32_dpp v56, v58 row_ror:8 row_mask:0xf bank_mask:0xc
    v_mov_b32_dpp v57, v59 row_ror:8 row_mask:0xf bank_mask:0xc
    v_mov_b32_dpp v60, v62 row_ror:8 row_mask:0xf bank_mask:0xc
    v_mov_b32_dpp v61, v63 row_ror:8 row_mask:0xf bank_mask:0xc
    v_mov_b32_dpp v58, v128 row_ror:8 row_mask:0xf bank_mask:0x3
    v_mov_b32_dpp v59, v129 row_ror:8 row_mask:0xf bank_mask:0x3
    v_mov_b32_dpp v62, v130 row_ror:8 row_mask:0xf bank_mask:0x3
    v_mov_b32_dpp v63, v131 row_ror:8 row_mask:0xf bank_mask:0x3
    v_perm_b32 v74, v60, v56, s12
    v_perm_b32 v78, v60, v56, s13
    v_perm_b32 v82, v61, v57, s12
    v_perm_b32 v86, v61, v57, s13
    v_perm_b32 v90, v62, v58, s12
    v_perm_b32 v94, v62, v58, s13
    v_perm_b32 v98, v63, v59, s12
    v_perm_b32 v102, v63, v59, s13
    s_waitcnt vmcnt(3)
    s_waitcnt vmcnt(2)
    v_mov_b32 v132, v64
    v_mov_b32 v133, v65
    v_mov_b32 v134, v68
    v_mov_b32 v135, v69
    v_mov_b32_dpp v64, v66 row_ror:8 row_mask:0xf bank_mask:0xc
    v_mov_b32_dpp v65, v67 row_ror:8 row_mask:0xf bank_mask:0xc
    v_mov_b32_dpp v68, v70 row_ror:8 row_mask:0xf bank_mask:0xc
    v_mov_b32_dpp v69, v71 row_ror:8 row_mask:0xf bank_mask:0xc
    v_mov_b32_dpp v66, v132 row_ror:8 row_mask:0xf bank_mask:0x3
    v_mov_b32_dpp v67, v133 row_ror:8 row_mask:0xf bank_mask:0x3
    v_mov_b32_dpp v70, v134 row_ror:8 row_mask:0xf bank_mask:0x3
    v_mov_b32_dpp v71, v135 row_ror:8 row_mask:0xf bank_mask:0x3
    v_perm_b32 v75, v68, v64, s12
    v_perm_b32 v79, v68, v64, s13
    v_perm_b32 v83, v69, v65, s12
    v_perm_b32 v87, v69, v65, s13
    v_perm_b32 v91, v70, v66, s12
    v_perm_b32 v95, v70, v66, s13
    v_perm_b32 v99, v71, v67, s12
    v_perm_b32 v103, v71, v67, s13
    v_lshlrev_b32 v116, 16, v116
    s_waitcnt vmcnt(0)
    s_mov_b32 s11, 400000
    v_max3_u32 v3, v16, v17, v18
    v_max3_u32 v3, v3, v19, v20
    v_max3_u32 v3, v3, v21, v22
    v_max_u32 v3, v3, v23
    v_cmp_eq_u32 vcc, -1, v3
    s_nop 0
    s_and_b64 exec, exec, vcc
    s_cbranch_scc0 L_opoll_ok
L_opoll:
    buffer_load_dwordx4 v[16:19], v9, s[52:55], s14 offen offset:0 sc1
    buffer_load_dwordx4 v[20:23], v9, s[52:55], s14 offen offset:1024 sc1
    s_waitcnt vmcnt(0)
    v_max3_u32 v3, v16, v17, v18
    v_max3_u32 v3, v3, v19, v20
    v_max3_u32 v3, v3, v21, v22
    v_max_u32 v3, v3, v23
    v_cmp_eq_u32 vcc, -1, v3
    s_nop 0
    s_and_b64 exec, exec, vcc
    s_cbranch_scc0 L_opoll_ok
    s_sub_u32 s11, s11, 1
    s_cmp_lg_u32 s11, 0
    s_cbranch_scc1 L_opoll
L_opoll_ok:
    s_mov_b64 exec, -1
    v_mfma_f32_16x16x32_bf16 v[24:27], v[16:19], v[72:75], 0
    v_mfma_f32_16x16x32_bf16 v[24:27], v[20:23], v[88:91], v[24:27]
    v_mfma_f32_16x16x32_bf16 v[28:31], v[16:19], v[76:79], 0
    v_mfma_f32_16x16x32_bf16 v[28:31], v[20:23], v[92:95], v[28:31]
    v_mfma_f32_16x16x32_bf16 v[32:35], v[16:19], v[80:83], 0
    v_mfma_f32_16x16x32_bf16 v[32:35], v[20:23], v[96:99], v[32:35]
    v_mfma_f32_16x16x32_bf16 v[36:39], v[16:19], v[84:87], 0
    v_mfma_f32_16x16x32_bf16 v[36:39], v[20:23], v[100:103], v[36:39]
    s_cmp_lt_u32 s101, 2
    s_cbranch_scc1 L_nopre
    s_mov_b32 exec_hi, 0xffff
    buffer_load_dwordx2 v[108:109], v10, s[52:55], s15 offen sc1
    s_mov_b32 exec_hi, -1
L_nopre:
    v_add_f32 v40, v24, v25
    v_add_f32 v44, v26, v27
    v_add_f32 v41, v28, v29
    v_add_f32 v45, v30, v31
    v_add_f32 v42, v32, v33
    v_add_f32 v46, v34, v35
    v_add_f32 v43, v36, v37
    v_add_f32 v47, v38, v39
    ds_write_b128 v5, v[40:43] offset:8192
    ds_write_b128 v5, v[44:47] offset:9216
    s_waitcnt lgkmcnt(0)
    s_barrier
    s_cmp_ge_u32 s101, 2
    s_cbranch_scc1 L_final
    ds_read_b128 v[24:27], v6 offset:8192
    ds_read_b128 v[28:31], v6 offset:10240
    ds_read_b128 v[32:35], v6 offset:12288
    ds_read_b128 v[36:39], v6 offset:14336
    s_waitcnt lgkmcnt(2)
    v_pk_add_f32 v[24:25], v[24:25], v[28:29]
    v_pk_add_f32 v[26:27], v[26:27], v[30:31]
    s_waitcnt lgkmcnt(0)
    v_pk_add_f32 v[32:33], v[32:33], v[36:37]
    v_pk_add_f32 v[34:35], v[34:35], v[38:39]
    v_pk_add_f32 v[24:25], v[24:25], v[32:33]
    v_pk_add_f32 v[26:27], v[26:27], v[34:35]
    v_cvt_pk_bf16_f32 v24, v24, v25
    v_cvt_pk_bf16_f32 v25, v26, v27
    v_min_u32 v24, -2, v24
    v_min_u32 v25, -2, v25
    s_cmp_eq_u32 s100, 0
    s_cbranch_scc1 L_far16
    buffer_store_dwordx2 v[24:25], v7, s[52:55], s73 offen
    s_branch L_sent17
L_far16:
    buffer_store_dwordx2 v[24:25], v7, s[52:55], s73 offen sc1
L_sent17:
    s_branch L_hdone
L_final:
    s_waitcnt vmcnt(0)
    s_mov_b32 s11, 400000
    v_max_u32 v3, v108, v109
    v_cmp_eq_u32 vcc, -1, v3
    s_nop 0
    s_and_b64 exec, exec, vcc
    s_cbranch_scc0 L_ypoll_ok
L_ypoll:
    buffer_load_dwordx2 v[108:109], v10, s[52:55], s15 offen sc1
    s_waitcnt vmcnt(0)
    v_max_u32 v3, v108, v109
    v_cmp_eq_u32 vcc, -1, v3
    s_nop 0
    s_and_b64 exec, exec, vcc
    s_cbranch_scc0 L_ypoll_ok
    s_sub_u32 s11, s11, 1
    s_cmp_lg_u32 s11, 0
    s_cbranch_scc1 L_ypoll
L_ypoll_ok:
    s_mov_b64 exec, -1
    buffer_load_dwordx2 v[104:105], v10, s[52:55], s74 offen sc1
    v_lshlrev_b32 v110, 16, v109
    v_and_b32 v111, 0xffff0000, v109
    v_and_b32 v109, 0xffff0000, v108
    v_lshlrev_b32 v108, 16, v108
    s_nop 1
    v_permlane32_swap_b32 v108, v110
    v_permlane32_swap_b32 v109, v111
    v_pk_add_f32 v[108:109], v[108:109], v[110:111]
    s_nop 1
    v_permlane16_swap_b32 v108, v109
    v_add_f32 v108, v108, v109
    s_nop 1
    v_add_f32_dpp v108, v108, v108 row_ror:8 row_mask:0xf bank_mask:0xf
    s_nop 1
    v_add_f32_dpp v108, v108, v108 row_ror:4 row_mask:0xf bank_mask:0xf
    v_cvt_pk_bf16_f32 v108, v108, v108
    v_and_b32 v108, 0xffff0000, v108
    s_mov_b32 s11, 400000
L_pp:
    buffer_load_dwordx2 v[112:113], v10, s[52:55], s74 offen sc1
    s_waitcnt vmcnt(1)
    v_max_u32 v3, v104, v105
    v_cmp_eq_u32 vcc, -1, v3
    s_nop 0
    s_cmp_eq_u64 vcc, 0
    s_cbranch_scc1 L_ppa
    buffer_load_dwordx2 v[104:105], v10, s[52:55], s74 offen sc1
    s_waitcnt vmcnt(1)
    v_max_u32 v3, v112, v113
    v_cmp_eq_u32 vcc, -1, v3
    s_nop 0
    s_cmp_eq_u64 vcc, 0
    s_cbranch_scc1 L_ppb
    s_sub_u32 s11, s11, 1
    s_cmp_lg_u32 s11, 0
    s_cbranch_scc1 L_pp
L_ppb:
    v_lshlrev_b32 v114, 16, v113
    v_and_b32 v115, 0xffff0000, v113
    v_and_b32 v113, 0xffff0000, v112
    v_lshlrev_b32 v112, 16, v112
    s_nop 1
    v_permlane32_swap_b32 v112, v114
    v_permlane32_swap_b32 v113, v115
    v_pk_add_f32 v[112:113], v[112:113], v[114:115]
    s_nop 1
    v_permlane16_swap_b32 v112, v113
    v_add_f32 v112, v112, v113
    s_nop 1
    v_add_f32_dpp v112, v112, v112 row_ror:8 row_mask:0xf bank_mask:0xf
    s_nop 1
    v_add_f32_dpp v112, v112, v112 row_ror:4 row_mask:0xf bank_mask:0xf
    v_cvt_pk_bf16_f32 v112, v112, v112
    v_and_b32 v112, 0xffff0000, v112
    v_add_f32 v4, v116, v112
    s_branch L_ppe
L_ppa:
    v_lshlrev_b32 v106, 16, v105
    v_and_b32 v107, 0xffff0000, v105
    v_and_b32 v105, 0xffff0000, v104
    v_lshlrev_b32 v104, 16, v104
    s_nop 1
    v_permlane32_swap_b32 v104, v106
    v_permlane32_swap_b32 v105, v107
    v_pk_add_f32 v[104:105], v[104:105], v[106:107]
    s_nop 1
    v_permlane16_swap_b32 v104, v105
    v_add_f32 v104, v104, v105
    s_nop 1
    v_add_f32_dpp v104, v104, v104 row_ror:8 row_mask:0xf bank_mask:0xf
    s_nop 1
    v_add_f32_dpp v104, v104, v104 row_ror:4 row_mask:0xf bank_mask:0xf
    v_cvt_pk_bf16_f32 v104, v104, v104
    v_and_b32 v104, 0xffff0000, v104
    v_add_f32 v4, v116, v104
L_ppe:
    v_cvt_pk_bf16_f32 v4, v4, v4
    v_and_b32 v4, 0xffff0000, v4
    v_add_f32 v4, v4, v108
    v_cvt_pk_bf16_f32 v4, v4, v4
    s_mov_b32 exec_lo, 0x000f000f
    s_mov_b32 exec_hi, 0x000f000f
    buffer_store_short v4, v11, s[68:71], s75 offen
    s_branch L_hdone
L_down:
    s_mov_b32 s60, s32
    s_mov_b32 s61, s33
    s_mov_b32 s62, 5308416
    s_mov_b32 s63, 0x20000
    v_lshrrev_b32 v3, 3, v0
    v_mul_u32_u24 v2, 9216, v3
    v_and_b32 v4, 7, v0
    v_lshl_add_u32 v2, v4, 4, v2
    s_sub_u32 s4, s8, 16
    s_mul_i32 s4, s4, 3
    s_add_u32 s4, s4, s101
    s_mul_i32 s72, s4, 147456
    s_lshl_b32 s5, s9, 7
    s_add_u32 s72, s72, s5
    s_lshl_b32 s14, s4, 11
    s_add_u32 s14, s14, 294912
    v_mov_b32 v9, v1
    v_lshrrev_b32 v3, 4, v0
    v_and_b32 v4, 15, v0
    v_mul_u32_u24 v7, 3584, v3
    v_lshl_add_u32 v7, v4, 3, v7
    v_lshlrev_b32 v6, 7, v3
    v_bfe_u32 v3, v0, 1, 3
    v_lshl_or_b32 v6, v3, 4, v6
    v_and_b32 v3, 1, v0
    v_lshl_or_b32 v6, v3, 10, v6
    s_lshl_b32 s4, s101, 9
    v_add_u32 v6, s4, v6
    s_mul_i32 s4, s101, 14336
    s_add_u32 s73, s73, s4
    s_barrier
    s_add_u32 s5, s72, 0
    buffer_load_dwordx4 v[64:67], v2, s[60:63], s5 offen offset:0 nt
    buffer_load_dwordx4 v[68:71], v2, s[60:63], s5 offen offset:1152 nt
    buffer_load_dwordx4 v[72:75], v2, s[60:63], s5 offen offset:2304 nt
    buffer_load_dwordx4 v[76:79], v2, s[60:63], s5 offen offset:3456 nt
    s_add_u32 s5, s72, 4608
    buffer_load_dwordx4 v[80:83], v2, s[60:63], s5 offen offset:0 nt
    buffer_load_dwordx4 v[84:87], v2, s[60:63], s5 offen offset:1152 nt
    buffer_load_dwordx4 v[88:91], v2, s[60:63], s5 offen offset:2304 nt
    buffer_load_dwordx4 v[92:95], v2, s[60:63], s5 offen offset:3456 nt
    s_add_u32 s5, s72, 73728
    buffer_load_dwordx4 v[96:99], v2, s[60:63], s5 offen offset:0 nt
    buffer_load_dwordx4 v[16:19], v9, s[52:55], s14 offen offset:0 sc1
    buffer_load_dwordx4 v[20:23], v9, s[52:55], s14 offen offset:1024 sc1
    v_mov_b32 v14, 0
    ds_read_b32 v14, v14 offset:0
    s_waitcnt lgkmcnt(0)
    v_readfirstlane_b32 s100, v14
    s_nop 0
    s_and_b32 s100, s100, 1
    s_cmp_lt_u32 s2, 224
    s_cselect_b32 s100, s100, 0
    s_barrier
    s_barrier
    buffer_load_dwordx4 v[100:103], v2, s[60:63], s5 offen offset:1152 nt
    buffer_load_dwordx4 v[104:107], v2, s[60:63], s5 offen offset:2304 nt
    buffer_load_dwordx4 v[108:111], v2, s[60:63], s5 offen offset:3456 nt
    s_add_u32 s5, s72, 78336
    buffer_load_dwordx4 v[112:115], v2, s[60:63], s5 offen offset:0 nt
    buffer_load_dwordx4 v[116:119], v2, s[60:63], s5 offen offset:1152 nt
    buffer_load_dwordx4 v[120:123], v2, s[60:63], s5 offen offset:2304 nt
    buffer_load_dwordx4 v[124:127], v2, s[60:63], s5 offen offset:3456 nt
    s_waitcnt vmcnt(16)
    v_perm_b32 v128, v68, v64, s12
    v_perm_b32 v132, v68, v64, s13
    v_perm_b32 v136, v69, v65, s12
    v_perm_b32 v140, v69, v65, s13
    v_perm_b32 v144, v70, v66, s12
    v_perm_b32 v148, v70, v66, s13
    v_perm_b32 v152, v71, v67, s12
    v_perm_b32 v156, v71, v67, s13
    s_waitcnt vmcnt(14)
    v_perm_b32 v129, v76, v72, s12
    v_perm_b32 v133, v76, v72, s13
    v_perm_b32 v137, v77, v73, s12
    v_perm_b32 v141, v77, v73, s13
    v_perm_b32 v145, v78, v74, s12
    v_perm_b32 v149, v78, v74, s13
    v_perm_b32 v153, v79, v75, s12
    v_perm_b32 v157, v79, v75, s13
    s_waitcnt vmcnt(12)
    v_perm_b32 v130, v84, v80, s12
    v_perm_b32 v134, v84, v80, s13
    v_perm_b32 v138, v85, v81, s12
    v_perm_b32 v142, v85, v81, s13
    v_perm_b32 v146, v86, v82, s12
    v_perm_b32 v150, v86, v82, s13
    v_perm_b32 v154, v87, v83, s12
    v_perm_b32 v158, v87, v83, s13
    s_waitcnt vmcnt(10)
    s_waitcnt vmcnt(7)
    s_mov_b32 s11, 400000
    v_max3_u32 v3, v16, v17, v18
    v_max3_u32 v3, v3, v19, v20
    v_max3_u32 v3, v3, v21, v22
    v_max_u32 v3, v3, v23
    v_cmp_eq_u32 vcc, -1, v3
    s_nop 0
    s_and_b64 exec, exec, vcc
    s_cbranch_scc0 L_hpoll_ok
L_hpoll:
    buffer_load_dwordx4 v[16:19], v9, s[52:55], s14 offen offset:0 sc1
    buffer_load_dwordx4 v[20:23], v9, s[52:55], s14 offen offset:1024 sc1
    s_waitcnt vmcnt(0)
    v_max3_u32 v3, v16, v17, v18
    v_max3_u32 v3, v3, v19, v20
    v_max3_u32 v3, v3, v21, v22
    v_max_u32 v3, v3, v23
    v_cmp_eq_u32 vcc, -1, v3
    s_nop 0
    s_and_b64 exec, exec, vcc
    s_cbranch_scc0 L_hpoll_ok
    s_sub_u32 s11, s11, 1
    s_cmp_lg_u32 s11, 0
    s_cbranch_scc1 L_hpoll
L_hpoll_ok:
    s_mov_b64 exec, -1
    v_perm_b32 v131, v92, v88, s12
    v_perm_b32 v135, v92, v88, s13
    v_perm_b32 v139, v93, v89, s12
    v_mfma_f32_16x16x32_bf16 v[24:27], v[16:19], v[128:131], 0
    v_perm_b32 v143, v93, v89, s13
    v_mfma_f32_16x16x32_bf16 v[28:31], v[16:19], v[132:135], 0
    v_perm_b32 v147, v94, v90, s12
    v_mfma_f32_16x16x32_bf16 v[32:35], v[16:19], v[136:139], 0
    v_perm_b32 v151, v94, v90, s13
    v_mfma_f32_16x16x32_bf16 v[36:39], v[16:19], v[140:143], 0
    v_perm_b32 v155, v95, v91, s12
    v_mfma_f32_16x16x32_bf16 v[40:43], v[16:19], v[144:147], 0
    v_perm_b32 v159, v95, v91, s13
    v_mfma_f32_16x16x32_bf16 v[44:47], v[16:19], v[148:151], 0
    v_mfma_f32_16x16x32_bf16 v[48:51], v[16:19], v[152:155], 0
    v_mfma_f32_16x16x32_bf16 v[52:55], v[16:19], v[156:159], 0
    s_waitcnt vmcnt(6)
    v_perm_b32 v160, v100, v96, s12
    v_perm_b32 v164, v100, v96, s13
    v_perm_b32 v168, v101, v97, s12
    v_perm_b32 v172, v101, v97, s13
    v_perm_b32 v176, v102, v98, s12
    v_perm_b32 v180, v102, v98, s13
    v_perm_b32 v184, v103, v99, s12
    v_perm_b32 v188, v103, v99, s13
    s_waitcnt vmcnt(4)
    v_perm_b32 v161, v108, v104, s12
    v_perm_b32 v165, v108, v104, s13
    v_perm_b32 v169, v109, v105, s12
    v_perm_b32 v173, v109, v105, s13
    v_perm_b32 v177, v110, v106, s12
    v_perm_b32 v181, v110, v106, s13
    v_perm_b32 v185, v111, v107, s12
    v_perm_b32 v189, v111, v107, s13
    s_waitcnt vmcnt(2)
    v_perm_b32 v162, v116, v112, s12
    v_perm_b32 v166, v116, v112, s13
    v_perm_b32 v170, v117, v113, s12
    v_perm_b32 v174, v117, v113, s13
    v_perm_b32 v178, v118, v114, s12
    v_perm_b32 v182, v118, v114, s13
    v_perm_b32 v186, v119, v115, s12
    v_perm_b32 v190, v119, v115, s13
    s_waitcnt vmcnt(0)
    v_perm_b32 v163, v124, v120, s12
    v_perm_b32 v167, v124, v120, s13
    v_perm_b32 v171, v125, v121, s12
    v_mfma_f32_16x16x32_bf16 v[24:27], v[20:23], v[160:163], v[24:27]
    v_perm_b32 v175, v125, v121, s13
    v_mfma_f32_16x16x32_bf16 v[28:31], v[20:23], v[164:167], v[28:31]
    v_perm_b32 v179, v126, v122, s12
    v_mfma_f32_16x16x32_bf16 v[32:35], v[20:23], v[168:171], v[32:35]
    v_perm_b32 v183, v126, v122, s13
    v_mfma_f32_16x16x32_bf16 v[36:39], v[20:23], v[172:175], v[36:39]
    v_perm_b32 v187, v127, v123, s12
    v_mfma_f32_16x16x32_bf16 v[40:43], v[20:23], v[176:179], v[40:43]
    v_perm_b32 v191, v127, v123, s13
    v_mfma_f32_16x16x32_bf16 v[44:47], v[20:23], v[180:183], v[44:47]
    v_mfma_f32_16x16x32_bf16 v[48:51], v[20:23], v[184:187], v[48:51]
    v_mfma_f32_16x16x32_bf16 v[52:55], v[20:23], v[188:191], v[52:55]
    v_add_f32_dpp v56, v25, v24 row_ror:8 row_mask:0xf bank_mask:0x3
    v_add_f32_dpp v57, v29, v28 row_ror:8 row_mask:0xf bank_mask:0x3
    v_add_f32_dpp v58, v33, v32 row_ror:8 row_mask:0xf bank_mask:0x3
    v_add_f32_dpp v59, v37, v36 row_ror:8 row_mask:0xf bank_mask:0x3
    v_add_f32_dpp v60, v41, v40 row_ror:8 row_mask:0xf bank_mask:0x3
    s_nop 0
    v_add_f32_dpp v61, v45, v44 row_ror:8 row_mask:0xf bank_mask:0x3
    v_add_f32_dpp v62, v49, v48 row_ror:8 row_mask:0xf bank_mask:0x3
    v_add_f32_dpp v63, v53, v52 row_ror:8 row_mask:0xf bank_mask:0x3
    v_add_f32_dpp v56, v26, v27 row_ror:8 row_mask:0xf bank_mask:0xc
    v_add_f32_dpp v57, v30, v31 row_ror:8 row_mask:0xf bank_mask:0xc
    v_add_f32_dpp v58, v34, v35 row_ror:8 row_mask:0xf bank_mask:0xc
    v_add_f32_dpp v59, v38, v39 row_ror:8 row_mask:0xf bank_mask:0xc
    v_add_f32_dpp v60, v42, v43 row_ror:8 row_mask:0xf bank_mask:0xc
    v_add_f32_dpp v61, v46, v47 row_ror:8 row_mask:0xf bank_mask:0xc
    v_add_f32_dpp v62, v50, v51 row_ror:8 row_mask:0xf bank_mask:0xc
    v_add_f32_dpp v63, v54, v55 row_ror:8 row_mask:0xf bank_mask:0xc
    ds_write_b128 v5, v[56:59] offset:8192
    ds_write_b128 v5, v[60:63] offset:9216
    s_waitcnt lgkmcnt(0)
    s_barrier
    s_cmp_ge_u32 s101, 2
    s_cbranch_scc1 L_hdone
    ds_read_b128 v[24:27], v6 offset:8192
    ds_read_b128 v[28:31], v6 offset:10240
    ds_read_b128 v[32:35], v6 offset:12288
    s_waitcnt lgkmcnt(1)
    v_pk_add_f32 v[24:25], v[24:25], v[28:29]
    v_pk_add_f32 v[26:27], v[26:27], v[30:31]
    s_waitcnt lgkmcnt(0)
    v_pk_add_f32 v[24:25], v[24:25], v[32:33]
    v_pk_add_f32 v[26:27], v[26:27], v[34:35]
    v_cvt_pk_bf16_f32 v24, v24, v25
    v_cvt_pk_bf16_f32 v25, v26, v27
    v_min_u32 v24, -2, v24
    v_min_u32 v25, -2, v25
    s_cmp_eq_u32 s100, 0
    s_cbranch_scc1 L_far18
    buffer_store_dwordx2 v[24:25], v7, s[52:55], s73 offen
    s_branch L_sent19
L_far18:
    buffer_store_dwordx2 v[24:25], v7, s[52:55], s73 offen sc1
L_sent19:
L_hdone:
L_end:
    s_endpgm
L_codeend:
.section .rodata,"a"
.p2align 6
.amdhsa_kernel parallel_sum__sliding_block_cached__geglu_ffn__decode_kernel
  .amdhsa_next_free_vgpr 256
  .amdhsa_next_free_sgpr 102
  .amdhsa_accum_offset 256
  .amdhsa_group_segment_fixed_size 0
  .amdhsa_kernarg_size 96
  .amdhsa_user_sgpr_count 2
  .amdhsa_user_sgpr_kernarg_segment_ptr 1
  .amdhsa_system_sgpr_workgroup_id_x 1
.end_amdhsa_kernel
```
